```python
import torch

def _softmax(x, axis=-1):
    return torch.softmax(x, dim=axis)
def _gelu(x):
    return torch.nn.functional.gelu(x, approximate="tanh")
def _silu(x):
    return torch.nn.functional.silu(x)
def _sigmoid(x):
    return torch.sigmoid(x)
def _layernorm(x, axis=-1, eps=1e-5):
    m = x.mean(dim=axis, keepdim=True)
    v = x.var(dim=axis, keepdim=True, unbiased=False)
    return (x - m) / torch.sqrt(v + eps)
def _scatter_add(tgt, idx, src, axis=0):
    return tgt.clone().index_add_(axis, idx, src)
def _segment_sum(src, seg, n):
    out = torch.zeros((n,) + src.shape[1:], dtype=src.dtype)
    return out.index_add_(0, seg, src)
def _pad(x, pw):
    flat = tuple(v for pair in reversed(pw) for v in pair)
    return torch.nn.functional.pad(x, flat)

kernel_name = 'gated_mix__softmax_full_mha__glu_gated_bilinear__prompt'

def setup_inputs():

    _w = (lambda a: (lambda t: t.to(torch.bfloat16) if t.is_floating_point() else t)(torch.as_tensor(a)))
    def _A_setup():
        B, S, D = 1, 2048, 512
        return {
            "x": _w((lambda *s: torch.randn(*s, dtype=torch.bfloat16) * 0.05)(B, S, D)),
            "wqkv": _w((lambda *s: torch.randn(*s, dtype=torch.bfloat16) * 0.8)(D, 3 * D)),
            "wo": _w((lambda *s: torch.randn(*s, dtype=torch.bfloat16) * 0.05)(D, D)),
        }
    _A_in = _A_setup()

    def _B_setup():
        B, S, D, F = 1, 2048, 512, 1792
        return {
            "x": _w((lambda *s: torch.randn(*s, dtype=torch.bfloat16) * 0.05)(B, S, D)),
            "w_gate": _w((lambda *s: torch.randn(*s, dtype=torch.bfloat16) * 1.6)(D, F) * (D ** -0.5)),
            "w_up": _w((lambda *s: torch.randn(*s, dtype=torch.bfloat16) * 1.6)(D, F) * (D ** -0.5)),
            "w_down": _w((lambda *s: torch.randn(*s, dtype=torch.bfloat16) * 1.6)(F, D) * (F ** -0.5)),
        }
    _B_in = _B_setup()

    return {
        "A_x": _A_in["x"],
        "A_wqkv": _A_in["wqkv"],
        "A_wo": _A_in["wo"],
        "B_x": _B_in["x"],
        "B_w_gate": _B_in["w_gate"],
        "B_w_up": _B_in["w_up"],
        "B_w_down": _B_in["w_down"],
        "gate_w": _w((lambda *s: torch.randn(*s, dtype=torch.bfloat16) * 0.05)(512) * 16.0),
    }

def reference(A_x, A_wqkv, A_wo, B_x, B_w_gate, B_w_up, B_w_down, gate_w):
    def _A_ref(x, wqkv, wo):
        B, S, D = x.shape
        H = 32; Dh = D // H
        qkv = (lambda x, *d: x.permute(*d))((x @ wqkv).reshape(B, S, 3, H, Dh), 2, 0, 3, 1, 4)
        q, k, v = qkv[0], qkv[1], qkv[2]
        scale = Dh ** -0.5
        scores = torch.einsum("bhqd,bhkd->bhqk", q, k) * scale
        p = _softmax(scores, axis=-1)
        o = torch.einsum("bhqk,bhkd->bhqd", p, v)
        return (lambda x, *d: x.permute(*d))(o, 0, 2, 1, 3).reshape(B, S, D) @ wo

    def _B_ref(x, w_gate, w_up, w_down):
        g = torch.einsum("bsd,df->bsf", x, w_gate)
        u = torch.einsum("bsd,df->bsf", x, w_up)
        h = g * u
        return torch.einsum("bsf,fd->bsd", h, w_down)

    x = A_x
    g = _sigmoid((x * gate_w).sum(-1, keepdims=True))
    a = _A_ref(x, A_wqkv, A_wo)
    b = _B_ref(x, B_w_gate, B_w_up, B_w_down)
    return g * a + (1 - g) * b
```

```asm
; @launch grid=(256,1,1) block=(512,1,1) lds=163840
.amdgcn_target "amdgcn-amd-amdhsa--gfx950"
.text
    .globl gated_mix__softmax_full_mha__glu_gated_bilinear__prompt_kernel
    .p2align 8
    .type gated_mix__softmax_full_mha__glu_gated_bilinear__prompt_kernel,@function
gated_mix__softmax_full_mha__glu_gated_bilinear__prompt_kernel:
    s_load_dwordx16 s[80:95], s[0:1], 0
    s_load_dwordx4 s[96:99], s[0:1], 64
    s_load_dwordx2 s[100:101], s[0:1], 80
    s_cmp_ge_u32 s2, 256
    s_cbranch_scc1 L_done
    v_lshrrev_b32 v1, 6, v0
    v_and_b32 v2, 63, v0
    v_readfirstlane_b32 s36, v1
    s_bfe_u32 s44, s2, 0x30003
    s_lshr_b32 s38, s2, 6
    s_and_b32 s40, s2, 3
    s_lshl_b32 s37, s2, 1
    s_and_b32 s37, s37, 8
    s_add_u32 s37, s37, s44
    s_lshl_b32 s39, s38, 1
    s_add_u32 s39, s39, s44
    v_lshrrev_b32 v18, 3, v0
    s_lshl_b32 s56, s37, 7
    v_add_u32 v18, s56, v18
    v_lshlrev_b32_e64 v8, 10, v18
    v_bfe_u32 v18, v0, 4, 3
    v_and_b32 v19, 7, v0
    v_xor_b32 v18, v18, v19
    v_lshl_add_u32 v8, v18, 4, v8
    s_lshl_b32 s43, s36, 10
    s_mov_b32 s6, 2097152
    s_mov_b32 s7, 0x00020000
    s_mov_b32 s57, 131072
    s_cmp_eq_u32 s38, 3
    s_cselect_b32 s57, 32768, s57
    s_add_u32 s42, s43, s57
    s_and_b32 s69, s39, 7
    s_lshl_b32 s68, s69, 7
    s_mov_b32 m0, s42
    s_waitcnt lgkmcnt(0)
    s_mov_b32 s4, s80
    s_and_b32 s5, s81, 0xffff
    buffer_load_dwordx4 v8, s[4:7], s68 offen lds
    s_add_u32 m0, s42, 8192
    s_add_u32 s68, s68, 65536
    buffer_load_dwordx4 v8, s[4:7], s68 offen lds
    v_lshrrev_b32_e64 v18, 5, v0
    v_bfe_u32 v19, v0, 2, 2
    v_lshl_add_u32 v20, v18, 2, v19
    v_and_b32 v22, 3, v0
    v_lshlrev_b32 v22, 4, v22
    v_bfe_u32 v18, v0, 4, 1
    v_lshl_add_u32 v21, v18, 6, v22
    s_lshr_b32 s45, s38, 1
    s_lshl_b32 s45, s45, 10
    s_lshl_b32 s56, s40, 8
    s_add_u32 s45, s45, s56
    s_and_b32 s57, s38, 1
    s_lshl_b32 s57, s57, 7
    s_add_u32 s45, s45, s57
    v_mul_u32_u24 v9, 3072, v20
    v_add3_u32 v9, v9, v21, s45
    v_lshlrev_b32 v3, 4, v2
    v_lshl_add_u32 v23, v1, 2, v19
    v_lshrrev_b32_e64 v18, 4, v2
    v_lshl_add_u32 v24, v18, 6, v22
    s_add_u32 s56, s56, 2048
    v_mul_u32_u24 v14, 3072, v23
    v_add3_u32 v14, v14, v24, s56
    s_mov_b32 s78, 1572864
    s_mov_b32 s79, 0x00020000
    s_mov_b32 s76, s82
    s_and_b32 s77, s83, 0xffff
    s_mul_i32 s69, s69, 196608
    s_cmp_eq_u32 s38, 3
    s_cselect_b64 vcc, -1, 0
    v_cndmask_b32 v6, v9, v14, vcc
    s_add_u32 m0, s42, 16384
    s_cmp_lg_u32 s36, 7
    buffer_load_dwordx4 v6, s[76:79], s69 offen lds
    s_cbranch_scc1 L_pK
    s_getpc_b64 s[56:57]
L_pc:
    s_lshr_b32 s68, s2, 3
    s_lshl_b32 s68, s68, 11
    v_and_b32 v4, 15, v2
    v_lshlrev_b32 v4, 7, v4
    v_add_u32 v4, s68, v4
    v_min_u32 v4, L_end-L_pc-4, v4
    v_mov_b32_e64 v5, s57
    v_add_co_u32 v4, vcc, s56, v4
    v_addc_co_u32 v5, vcc, 0, v5, vcc
    global_load_dword v7, v[4:5], off
    s_cmp_lg_u32 s2, 0
    s_cbranch_scc1 L_pK
    s_mov_b32 s32, s98
    s_and_b32 s33, s99, 0xffff
    s_mov_b32 s34, 256
    s_mov_b32 s35, 0x00020000
    s_memrealtime s[56:57]
    s_waitcnt lgkmcnt(0)
    s_or_b32 s57, s57, 0x80000000
    v_mov_b32 v4, s56
    v_mov_b32 v5, s57
    v_mov_b32 v6, 0
    s_mov_b64 exec, 1
    buffer_store_dwordx2 v[4:5], v6, s[32:35], 0 offen sc1
    s_mov_b64 exec, -1
L_pK:
    s_cmp_lg_u32 s38, 3
    s_cbranch_scc1 LnR_1
    s_add_u32 m0, s42, 24576
    s_add_u32 s69, s69, 98304
    buffer_load_dwordx4 v14, s[76:79], s69 offen lds
    v_mov_b32 v23, v20
    v_mov_b32_e64 v24, v21
LnR_1:
    s_mul_i32 s45, s40, 896
    s_lshl_b32 s56, s38, 8
    s_add_u32 s45, s45, s56
    v_mul_u32_u24 v15, 3584, v23
    v_add3_u32 v15, v15, v24, s45
    s_mov_b32 s8, s88
    s_and_b32 s9, s89, 0xffff
    s_mov_b32 s10, 1835008
    s_mov_b32 s11, 0x00020000
    s_mov_b32 s12, s90
    s_and_b32 s13, s91, 0xffff
    s_mov_b32 s14, 1835008
    s_mov_b32 s15, 0x00020000
    s_mov_b32 s16, s100
    s_and_b32 s17, s101, 0xffff
    s_mov_b32 s18, 33554432
    s_mov_b32 s19, 0x00020000
    s_mov_b32 s20, s92
    s_and_b32 s21, s93, 0xffff
    s_mov_b32 s22, 1835008
    s_mov_b32 s23, 0x00020000
    s_mov_b32 s24, s84
    s_and_b32 s25, s85, 0xffff
    s_mov_b32 s26, 524288
    s_mov_b32 s27, 0x00020000
    s_mov_b32 s28, s96
    s_and_b32 s29, s97, 0xffff
    s_mov_b32 s30, 2097152
    s_mov_b32 s31, 0x00020000
    s_mov_b32 s32, s98
    s_and_b32 s33, s99, 0xffff
    s_mov_b32 s34, 256
    s_mov_b32 s35, 0x00020000
    s_mov_b32 s88, s94
    s_and_b32 s89, s95, 0xffff
    s_mov_b32 s90, 1024
    s_mov_b32 s91, 0x00020000
    s_cmp_lg_u32 s36, 6
    s_cbranch_scc1 Lw_2
    v_lshlrev_b32 v4, 21, v2
    v_lshlrev_b32 v5, 7, v2
    s_mov_b64 exec, 0xff
    buffer_load_dword v7, v5, s[88:91], 0 offen
    buffer_load_dword v7, v4, s[8:11], 0 offen
    buffer_load_dword v7, v4, s[12:15], 0 offen
    buffer_load_dword v7, v4, s[20:23], 0 offen
    buffer_load_dword v7, v4, s[24:27], 0 offen
    buffer_load_dword v7, v4, s[16:19], 0 offen sc1
    s_mov_b64 exec, -1
Lw_2:
    s_sub_u32 s57, s42, s43
    s_and_b32 s45, s36, 3
    s_lshl_b32 s41, s37, 2
    s_add_u32 s41, s41, s45
    s_lshl_b32 s45, s45, 12
    s_add_u32 s45, s45, s57
    v_and_b32 v18, 31, v2
    v_lshlrev_b32_e64 v10, 7, v18
    v_bfe_u32 v18, v2, 1, 3
    v_lshrrev_b32 v20, 5, v2
    v_xor_b32 v18, v18, v20
    v_lshl_add_u32 v10, v18, 4, v10
    v_xor_b32 v11, 32, v10
    v_xor_b32 v12, 64, v10
    v_xor_b32 v13, 96, v10
    v_add_u32 v10, s45, v10
    v_add_u32 v11, s45, v11
    v_add_u32 v12, s45, v12
    v_add_u32 v13, s45, v13
    v_lshlrev_b32_e64 v21, 6, v19
    v_bfe_u32 v18, v2, 4, 1
    v_lshl_add_u32 v21, v18, 5, v21
    v_lshrrev_b32_e64 v22, 1, v22
    v_add3_u32 v21, v21, v22, s57
    s_and_b32 s45, s36, 4
    s_lshl_b32 s56, s45, 6
    v_lshl_add_u32 v16, v20, 10, v21
    v_add_u32 v16, s56, v16
    s_lshl_b32 s56, s45, 7
    v_lshl_add_u32 v17, v20, 11, v21
    v_add_u32 v17, s56, v17
    s_and_b32 s44, s2, 7
    s_lshr_b32 s45, s2, 3
    s_lshl_b32 s46, s44, 2
    s_and_b32 s56, s45, 3
    s_add_u32 s46, s46, s56
    s_lshr_b32 s81, s45, 2
    s_lshl_b32 s47, s81, 3
    s_add_u32 s47, s47, s36
    s_lshl_b32 s81, s81, 14
    s_lshl_b32 s48, s44, 2
    s_add_u32 s48, s48, s38
    s_and_b32 s49, s45, 7
    s_lshl_b32 s44, s36, 11
    v_add_u32 v30, s44, v3
    s_lshl_b32 s59, s46, 17
    s_add_u32 s59, s59, 2097152
    s_cmp_eq_u32 s38, 3
    s_cbranch_scc1 L_R
    s_and_b32 s44, s36, 4
    s_lshl_b32 s44, s44, 3
    v_xor_b32 v15, s44, v15
    s_add_u32 s68, s39, 1
    s_and_b32 s68, s68, 7
    s_add_u32 m0, s43, 0
    s_mul_i32 s68, s68, 128
    buffer_load_dwordx4 v8, s[4:7], s68 offen lds
    s_add_u32 m0, s43, 8192
    s_add_u32 s68, s68, 65536
    buffer_load_dwordx4 v8, s[4:7], s68 offen lds
    s_add_u32 s68, s39, 1
    s_and_b32 s68, s68, 7
    s_add_u32 m0, s43, 16384
    s_mul_i32 s68, s68, 196608
    buffer_load_dwordx4 v9, s[76:79], s68 offen lds
    s_waitcnt vmcnt(3)
    s_barrier
    ds_read_b128 v[224:227], v10
    ds_read_b64_tr_b16 v[32:33], v16 offset:16384
    ds_read_b64_tr_b16 v[34:35], v16 offset:16896
    ds_read_b128 v[228:231], v11
    ds_read_b64_tr_b16 v[36:37], v16 offset:18432
    ds_read_b64_tr_b16 v[38:39], v16 offset:18944
    ds_read_b128 v[232:235], v12
    ds_read_b64_tr_b16 v[40:41], v16 offset:20480
    ds_read_b64_tr_b16 v[42:43], v16 offset:20992
    ds_read_b128 v[236:239], v13
    ds_read_b64_tr_b16 v[44:45], v16 offset:22528
    ds_read_b64_tr_b16 v[46:47], v16 offset:23040
    s_add_u32 s68, s39, 2
    s_and_b32 s68, s68, 7
    s_add_u32 m0, s43, 32768
    s_mul_i32 s68, s68, 128
    buffer_load_dwordx4 v8, s[4:7], s68 offen lds
    s_add_u32 m0, s43, 40960
    s_add_u32 s68, s68, 65536
    buffer_load_dwordx4 v8, s[4:7], s68 offen lds
    s_add_u32 s68, s39, 2
    s_and_b32 s68, s68, 7
    s_add_u32 m0, s43, 49152
    s_mul_i32 s68, s68, 196608
    buffer_load_dwordx4 v9, s[76:79], s68 offen lds
    s_waitcnt lgkmcnt(0)
    s_waitcnt vmcnt(3)
    s_barrier
    v_add_u32 v10, 4294836224, v10
    v_add_u32 v11, 4294836224, v11
    v_add_u32 v12, 4294836224, v12
    v_add_u32 v13, 4294836224, v13
    v_add_u32 v16, 4294836224, v16
    ds_read_b128 v[128:131], v10
    ds_read_b64_tr_b16 v[48:49], v16 offset:16384
    s_add_u32 s68, s39, 3
    s_and_b32 s68, s68, 7
    s_add_u32 m0, s43, 65536
    s_mul_i32 s68, s68, 128
    v_mfma_f32_32x32x16_bf16 v[240:255], v[32:35], v[224:227], 0
    buffer_load_dwordx4 v8, s[4:7], s68 offen lds
    ds_read_b64_tr_b16 v[50:51], v16 offset:16896
    ds_read_b128 v[132:135], v11
    ds_read_b64_tr_b16 v[52:53], v16 offset:18432
    s_add_u32 m0, s43, 73728
    s_add_u32 s68, s68, 65536
    v_mfma_f32_32x32x16_bf16 v[240:255], v[36:39], v[228:231], v[240:255]
    buffer_load_dwordx4 v8, s[4:7], s68 offen lds
    ds_read_b64_tr_b16 v[54:55], v16 offset:18944
    ds_read_b128 v[136:139], v12
    ds_read_b64_tr_b16 v[56:57], v16 offset:20480
    s_add_u32 s68, s39, 3
    s_and_b32 s68, s68, 7
    s_add_u32 m0, s43, 81920
    s_mul_i32 s68, s68, 196608
    v_mfma_f32_32x32x16_bf16 v[240:255], v[40:43], v[232:235], v[240:255]
    buffer_load_dwordx4 v9, s[76:79], s68 offen lds
    ds_read_b64_tr_b16 v[58:59], v16 offset:20992
    ds_read_b128 v[140:143], v13
    ds_read_b64_tr_b16 v[60:61], v16 offset:22528
    s_add_u32 s68, s39, 0
    s_and_b32 s68, s68, 7
    s_add_u32 m0, s43, 98304
    s_mul_i32 s68, s68, 229376
    v_mfma_f32_32x32x16_bf16 v[240:255], v[44:47], v[236:239], v[240:255]
    buffer_load_dwordx4 v15, s[8:11], s68 offen lds
    ds_read_b64_tr_b16 v[62:63], v16 offset:23040
    s_waitcnt lgkmcnt(0)
    s_waitcnt vmcnt(4)
    s_barrier
    v_add_u32 v10, 32768, v10
    v_add_u32 v11, 32768, v11
    v_add_u32 v12, 32768, v12
    v_add_u32 v13, 32768, v13
    v_add_u32 v16, 32768, v16
    ds_read_b128 v[144:147], v10
    ds_read_b64_tr_b16 v[32:33], v16 offset:16384
    s_add_u32 m0, s43, 114688
    v_mfma_f32_32x32x16_bf16 v[240:255], v[48:51], v[128:131], v[240:255]
    buffer_load_dwordx4 v15, s[12:15], s68 offen lds
    ds_read_b64_tr_b16 v[34:35], v16 offset:16896
    ds_read_b128 v[148:151], v11
    ds_read_b64_tr_b16 v[36:37], v16 offset:18432
    s_add_u32 m0, s43, 106496
    s_add_u32 s68, s68, 114688
    v_mfma_f32_32x32x16_bf16 v[240:255], v[52:55], v[132:135], v[240:255]
    buffer_load_dwordx4 v15, s[8:11], s68 offen lds
    ds_read_b64_tr_b16 v[38:39], v16 offset:18944
    ds_read_b128 v[152:155], v12
    ds_read_b64_tr_b16 v[40:41], v16 offset:20480
    s_add_u32 m0, s43, 122880
    v_mfma_f32_32x32x16_bf16 v[240:255], v[56:59], v[136:139], v[240:255]
    buffer_load_dwordx4 v15, s[12:15], s68 offen lds
    ds_read_b64_tr_b16 v[42:43], v16 offset:20992
    ds_read_b128 v[156:159], v13
    ds_read_b64_tr_b16 v[44:45], v16 offset:22528
    s_add_u32 s68, s39, 4
    s_and_b32 s68, s68, 7
    s_add_u32 m0, s43, 131072
    s_mul_i32 s68, s68, 128
    v_mfma_f32_32x32x16_bf16 v[240:255], v[60:63], v[140:143], v[240:255]
    buffer_load_dwordx4 v8, s[4:7], s68 offen lds
    ds_read_b64_tr_b16 v[46:47], v16 offset:23040
    v_mov_b32_e64 v18, 0
    buffer_load_dwordx2 v[26:27], v18, s[32:35], 0 offen sc1
    s_waitcnt vmcnt(6)
    s_barrier
    v_add_u32 v10, 32768, v10
    v_add_u32 v11, 32768, v11
    v_add_u32 v12, 32768, v12
    v_add_u32 v13, 32768, v13
    v_add_u32 v16, 32768, v16
    s_add_u32 m0, s43, 139264
    s_add_u32 s68, s68, 65536
    s_waitcnt lgkmcnt(9)
    v_mfma_f32_32x32x16_bf16 v[240:255], v[32:35], v[144:147], v[240:255]
    buffer_load_dwordx4 v8, s[4:7], s68 offen lds
    ds_read_b128 v[160:163], v10
    ds_read_b64_tr_b16 v[48:49], v16 offset:16384
    ds_read_b64_tr_b16 v[50:51], v16 offset:16896
    s_add_u32 s68, s39, 4
    s_and_b32 s68, s68, 7
    s_add_u32 m0, s43, 147456
    s_mul_i32 s68, s68, 196608
    s_waitcnt lgkmcnt(9)
    v_mfma_f32_32x32x16_bf16 v[240:255], v[36:39], v[148:151], v[240:255]
    buffer_load_dwordx4 v9, s[76:79], s68 offen lds
    ds_read_b128 v[164:167], v11
    ds_read_b64_tr_b16 v[52:53], v16 offset:18432
    ds_read_b64_tr_b16 v[54:55], v16 offset:18944
    s_add_u32 s68, s39, 5
    s_and_b32 s68, s68, 7
    s_add_u32 m0, s43, 0
    s_mul_i32 s68, s68, 128
    s_waitcnt lgkmcnt(9)
    v_mfma_f32_32x32x16_bf16 v[240:255], v[40:43], v[152:155], v[240:255]
    buffer_load_dwordx4 v8, s[4:7], s68 offen lds
    ds_read_b128 v[168:171], v12
    ds_read_b64_tr_b16 v[56:57], v16 offset:20480
    ds_read_b64_tr_b16 v[58:59], v16 offset:20992
    s_add_u32 m0, s43, 8192
    s_add_u32 s68, s68, 65536
    s_waitcnt lgkmcnt(9)
    v_mfma_f32_32x32x16_bf16 v[240:255], v[44:47], v[156:159], v[240:255]
    buffer_load_dwordx4 v8, s[4:7], s68 offen lds
    ds_read_b128 v[172:175], v13
    ds_read_b64_tr_b16 v[60:61], v16 offset:22528
    ds_read_b64_tr_b16 v[62:63], v16 offset:23040
    s_waitcnt vmcnt(6)
    s_barrier
    v_add_u32 v17, 4294934528, v17
    v_bfe_u32 v14, v2, 4, 1
    v_lshl_add_u32 v17, v14, 12, v17
    v_xor_b32 v14, 32, v17
    s_add_u32 s68, s39, 5
    s_and_b32 s68, s68, 7
    s_add_u32 m0, s43, 16384
    s_mul_i32 s68, s68, 196608
    s_waitcnt lgkmcnt(9)
    v_mfma_f32_32x32x16_bf16 v[240:255], v[48:51], v[160:163], v[240:255]
    buffer_load_dwordx4 v9, s[76:79], s68 offen lds
    ds_read_b64_tr_b16 v[32:33], v17 offset:0
    ds_read_b64_tr_b16 v[34:35], v17 offset:1024
    s_add_u32 s68, s39, 1
    s_and_b32 s68, s68, 7
    s_add_u32 m0, s43, 32768
    s_mul_i32 s68, s68, 229376
    s_waitcnt lgkmcnt(8)
    v_mfma_f32_32x32x16_bf16 v[240:255], v[52:55], v[164:167], v[240:255]
    buffer_load_dwordx4 v15, s[8:11], s68 offen lds
    ds_read_b64_tr_b16 v[36:37], v17 offset:16384
    ds_read_b64_tr_b16 v[38:39], v17 offset:17408
    v_permlane16_swap_b32 v224, v228
    v_permlane16_swap_b32 v225, v229
    v_permlane16_swap_b32 v226, v230
    v_permlane16_swap_b32 v227, v231
    s_add_u32 m0, s43, 49152
    s_waitcnt lgkmcnt(7)
    v_mfma_f32_32x32x16_bf16 v[240:255], v[56:59], v[168:171], v[240:255]
    buffer_load_dwordx4 v15, s[12:15], s68 offen lds
    ds_read_b64_tr_b16 v[40:41], v14 offset:0
    ds_read_b64_tr_b16 v[42:43], v14 offset:1024
    s_add_u32 m0, s43, 40960
    s_add_u32 s68, s68, 114688
    s_waitcnt lgkmcnt(6)
    v_mfma_f32_32x32x16_bf16 v[240:255], v[60:63], v[172:175], v[240:255]
    buffer_load_dwordx4 v15, s[8:11], s68 offen lds
    ds_read_b64_tr_b16 v[44:45], v14 offset:16384
    ds_read_b64_tr_b16 v[46:47], v14 offset:17408
    s_waitcnt lgkmcnt(6)
    v_mfma_f32_16x16x32_bf16 v[64:67], v[32:35], v[224:227], 0
    ds_read_b64_tr_b16 v[48:49], v17 offset:256
    ds_read_b64_tr_b16 v[50:51], v17 offset:1280
    v_mfma_f32_16x16x32_bf16 v[68:71], v[32:35], v[228:231], 0
    s_waitcnt lgkmcnt(6)
    v_mfma_f32_16x16x32_bf16 v[80:83], v[36:39], v[224:227], 0
    ds_read_b64_tr_b16 v[52:53], v17 offset:16640
    ds_read_b64_tr_b16 v[54:55], v17 offset:17664
    v_mfma_f32_16x16x32_bf16 v[84:87], v[36:39], v[228:231], 0
    s_waitcnt lgkmcnt(6)
    v_mfma_f32_16x16x32_bf16 v[72:75], v[40:43], v[224:227], 0
    ds_read_b64_tr_b16 v[56:57], v14 offset:256
    ds_read_b64_tr_b16 v[58:59], v14 offset:1280
    v_mfma_f32_16x16x32_bf16 v[76:79], v[40:43], v[228:231], 0
    s_add_u32 m0, s43, 57344
    s_waitcnt lgkmcnt(6)
    v_mfma_f32_16x16x32_bf16 v[88:91], v[44:47], v[224:227], 0
    ds_read_b64_tr_b16 v[60:61], v14 offset:16640
    ds_read_b64_tr_b16 v[62:63], v14 offset:17664
    v_mfma_f32_16x16x32_bf16 v[92:95], v[44:47], v[228:231], 0
    buffer_load_dwordx4 v15, s[12:15], s68 offen lds
    s_waitcnt lgkmcnt(6)
    v_mfma_f32_16x16x32_bf16 v[96:99], v[48:51], v[224:227], 0
    ds_read_b64_tr_b16 v[32:33], v17 offset:8192
    ds_read_b64_tr_b16 v[34:35], v17 offset:9216
    v_mfma_f32_16x16x32_bf16 v[100:103], v[48:51], v[228:231], 0
    s_waitcnt lgkmcnt(6)
    v_mfma_f32_16x16x32_bf16 v[112:115], v[52:55], v[224:227], 0
    ds_read_b64_tr_b16 v[36:37], v17 offset:24576
    ds_read_b64_tr_b16 v[38:39], v17 offset:25600
    v_mfma_f32_16x16x32_bf16 v[116:119], v[52:55], v[228:231], 0
    v_permlane16_swap_b32 v232, v236
    v_permlane16_swap_b32 v233, v237
    v_permlane16_swap_b32 v234, v238
    v_permlane16_swap_b32 v235, v239
    s_waitcnt lgkmcnt(6)
    v_mfma_f32_16x16x32_bf16 v[104:107], v[56:59], v[224:227], 0
    ds_read_b64_tr_b16 v[40:41], v14 offset:8192
    ds_read_b64_tr_b16 v[42:43], v14 offset:9216
    v_mfma_f32_16x16x32_bf16 v[108:111], v[56:59], v[228:231], 0
    s_waitcnt lgkmcnt(6)
    v_mfma_f32_16x16x32_bf16 v[120:123], v[60:63], v[224:227], 0
    ds_read_b64_tr_b16 v[44:45], v14 offset:24576
    ds_read_b64_tr_b16 v[46:47], v14 offset:25600
    v_mfma_f32_16x16x32_bf16 v[124:127], v[60:63], v[228:231], 0
    s_waitcnt lgkmcnt(6)
    v_mfma_f32_16x16x32_bf16 v[64:67], v[32:35], v[232:235], v[64:67]
    ds_read_b64_tr_b16 v[48:49], v17 offset:8448
    ds_read_b64_tr_b16 v[50:51], v17 offset:9472
    v_mfma_f32_16x16x32_bf16 v[68:71], v[32:35], v[236:239], v[68:71]
    s_waitcnt lgkmcnt(6)
    v_mfma_f32_16x16x32_bf16 v[80:83], v[36:39], v[232:235], v[80:83]
    ds_read_b64_tr_b16 v[52:53], v17 offset:24832
    ds_read_b64_tr_b16 v[54:55], v17 offset:25856
    v_mfma_f32_16x16x32_bf16 v[84:87], v[36:39], v[236:239], v[84:87]
    s_waitcnt lgkmcnt(6)
    v_mfma_f32_16x16x32_bf16 v[72:75], v[40:43], v[232:235], v[72:75]
    ds_read_b64_tr_b16 v[56:57], v14 offset:8448
    ds_read_b64_tr_b16 v[58:59], v14 offset:9472
    v_mfma_f32_16x16x32_bf16 v[76:79], v[40:43], v[236:239], v[76:79]
    s_waitcnt lgkmcnt(6)
    v_mfma_f32_16x16x32_bf16 v[88:91], v[44:47], v[232:235], v[88:91]
    ds_read_b64_tr_b16 v[60:61], v14 offset:24832
    ds_read_b64_tr_b16 v[62:63], v14 offset:25856
    v_mfma_f32_16x16x32_bf16 v[92:95], v[44:47], v[236:239], v[92:95]
    s_waitcnt vmcnt(7)
    s_barrier
    v_add_u32 v10, 65536, v10
    v_add_u32 v11, 65536, v11
    v_add_u32 v12, 65536, v12
    v_add_u32 v13, 65536, v13
    v_add_u32 v16, 65536, v16
    s_add_u32 s68, s39, 6
    s_and_b32 s68, s68, 7
    s_add_u32 m0, s43, 65536
    s_mul_i32 s68, s68, 128
    s_waitcnt lgkmcnt(6)
    v_mfma_f32_16x16x32_bf16 v[96:99], v[48:51], v[232:235], v[96:99]
    ds_read_b128 v[176:179], v10
    ds_read_b64_tr_b16 v[32:33], v16 offset:16384
    ds_read_b64_tr_b16 v[34:35], v16 offset:16896
    v_mfma_f32_16x16x32_bf16 v[100:103], v[48:51], v[236:239], v[100:103]
    buffer_load_dwordx4 v8, s[4:7], s68 offen lds
    s_waitcnt lgkmcnt(7)
    v_mfma_f32_16x16x32_bf16 v[112:115], v[52:55], v[232:235], v[112:115]
    ds_read_b128 v[180:183], v11
    ds_read_b64_tr_b16 v[36:37], v16 offset:18432
    ds_read_b64_tr_b16 v[38:39], v16 offset:18944
    v_mfma_f32_16x16x32_bf16 v[116:119], v[52:55], v[236:239], v[116:119]
    s_waitcnt lgkmcnt(8)
    v_mfma_f32_16x16x32_bf16 v[104:107], v[56:59], v[232:235], v[104:107]
    ds_read_b128 v[184:187], v12
    ds_read_b64_tr_b16 v[40:41], v16 offset:20480
    ds_read_b64_tr_b16 v[42:43], v16 offset:20992
    v_mfma_f32_16x16x32_bf16 v[108:111], v[56:59], v[236:239], v[108:111]
    s_waitcnt lgkmcnt(9)
    v_mfma_f32_16x16x32_bf16 v[120:123], v[60:63], v[232:235], v[120:123]
    ds_read_b128 v[188:191], v13
    ds_read_b64_tr_b16 v[44:45], v16 offset:22528
    ds_read_b64_tr_b16 v[46:47], v16 offset:23040
    v_mfma_f32_16x16x32_bf16 v[124:127], v[60:63], v[236:239], v[124:127]
    s_waitcnt vmcnt(5)
    s_barrier
    v_add_u32 v10, 4294836224, v10
    v_add_u32 v11, 4294836224, v11
    v_add_u32 v12, 4294836224, v12
    v_add_u32 v13, 4294836224, v13
    v_add_u32 v16, 4294836224, v16
    s_add_u32 m0, s43, 73728
    s_add_u32 s68, s68, 65536
    s_waitcnt lgkmcnt(9)
    v_mfma_f32_32x32x16_bf16 v[240:255], v[32:35], v[176:179], v[240:255]
    buffer_load_dwordx4 v8, s[4:7], s68 offen lds
    ds_read_b128 v[192:195], v10
    ds_read_b64_tr_b16 v[48:49], v16 offset:16384
    ds_read_b64_tr_b16 v[50:51], v16 offset:16896
    s_add_u32 s68, s39, 6
    s_and_b32 s68, s68, 7
    s_add_u32 m0, s43, 81920
    s_mul_i32 s68, s68, 196608
    s_waitcnt lgkmcnt(9)
    v_mfma_f32_32x32x16_bf16 v[240:255], v[36:39], v[180:183], v[240:255]
    buffer_load_dwordx4 v9, s[76:79], s68 offen lds
    ds_read_b128 v[196:199], v11
    ds_read_b64_tr_b16 v[52:53], v16 offset:18432
    ds_read_b64_tr_b16 v[54:55], v16 offset:18944
    s_add_u32 s68, s39, 7
    s_and_b32 s68, s68, 7
    s_add_u32 m0, s43, 98304
    s_mul_i32 s68, s68, 128
    s_waitcnt lgkmcnt(9)
    v_mfma_f32_32x32x16_bf16 v[240:255], v[40:43], v[184:187], v[240:255]
    buffer_load_dwordx4 v8, s[4:7], s68 offen lds
    ds_read_b128 v[200:203], v12
    ds_read_b64_tr_b16 v[56:57], v16 offset:20480
    ds_read_b64_tr_b16 v[58:59], v16 offset:20992
    s_add_u32 m0, s43, 106496
    s_add_u32 s68, s68, 65536
    s_waitcnt lgkmcnt(9)
    v_mfma_f32_32x32x16_bf16 v[240:255], v[44:47], v[188:191], v[240:255]
    buffer_load_dwordx4 v8, s[4:7], s68 offen lds
    ds_read_b128 v[204:207], v13
    ds_read_b64_tr_b16 v[60:61], v16 offset:22528
    ds_read_b64_tr_b16 v[62:63], v16 offset:23040
    s_waitcnt vmcnt(5)
    s_barrier
    v_add_u32 v17, 4294901760, v17
    v_xor_b32_e64 v14, 32, v17
    s_add_u32 s68, s39, 7
    s_and_b32 s68, s68, 7
    s_add_u32 m0, s43, 114688
    s_mul_i32 s68, s68, 196608
    s_waitcnt lgkmcnt(9)
    v_mfma_f32_32x32x16_bf16 v[240:255], v[48:51], v[192:195], v[240:255]
    buffer_load_dwordx4 v9, s[76:79], s68 offen lds
    ds_read_b64_tr_b16 v[32:33], v17 offset:0
    ds_read_b64_tr_b16 v[34:35], v17 offset:1024
    s_add_u32 s68, s39, 2
    s_and_b32 s68, s68, 7
    s_add_u32 m0, s43, 131072
    s_mul_i32 s68, s68, 229376
    s_waitcnt lgkmcnt(8)
    v_mfma_f32_32x32x16_bf16 v[240:255], v[52:55], v[196:199], v[240:255]
    buffer_load_dwordx4 v15, s[8:11], s68 offen lds
    ds_read_b64_tr_b16 v[36:37], v17 offset:16384
    ds_read_b64_tr_b16 v[38:39], v17 offset:17408
    v_permlane16_swap_b32 v128, v132
    v_permlane16_swap_b32 v129, v133
    v_permlane16_swap_b32 v130, v134
    v_permlane16_swap_b32 v131, v135
    s_add_u32 m0, s43, 147456
    s_waitcnt lgkmcnt(7)
    v_mfma_f32_32x32x16_bf16 v[240:255], v[56:59], v[200:203], v[240:255]
    buffer_load_dwordx4 v15, s[12:15], s68 offen lds
    ds_read_b64_tr_b16 v[40:41], v14 offset:0
    ds_read_b64_tr_b16 v[42:43], v14 offset:1024
    s_add_u32 m0, s43, 139264
    s_add_u32 s68, s68, 114688
    s_waitcnt lgkmcnt(6)
    v_mfma_f32_32x32x16_bf16 v[240:255], v[60:63], v[204:207], v[240:255]
    buffer_load_dwordx4 v15, s[8:11], s68 offen lds
    ds_read_b64_tr_b16 v[44:45], v14 offset:16384
    ds_read_b64_tr_b16 v[46:47], v14 offset:17408
    s_mov_b32 s58, 0x40000
Lchk_3:
    v_readfirstlane_b32 s54, v26
    v_readfirstlane_b32 s55, v27
    s_cmp_lg_u32 s55, 0
    s_cbranch_scc0 Lrt_4
Lok_5:
    s_waitcnt lgkmcnt(6)
    v_mfma_f32_16x16x32_bf16 v[64:67], v[32:35], v[128:131], v[64:67]
    ds_read_b64_tr_b16 v[48:49], v17 offset:256
    ds_read_b64_tr_b16 v[50:51], v17 offset:1280
    v_mfma_f32_16x16x32_bf16 v[68:71], v[32:35], v[132:135], v[68:71]
    s_waitcnt lgkmcnt(6)
    v_mfma_f32_16x16x32_bf16 v[80:83], v[36:39], v[128:131], v[80:83]
    ds_read_b64_tr_b16 v[52:53], v17 offset:16640
    ds_read_b64_tr_b16 v[54:55], v17 offset:17664
    v_mfma_f32_16x16x32_bf16 v[84:87], v[36:39], v[132:135], v[84:87]
    s_waitcnt lgkmcnt(6)
    v_mfma_f32_16x16x32_bf16 v[72:75], v[40:43], v[128:131], v[72:75]
    ds_read_b64_tr_b16 v[56:57], v14 offset:256
    ds_read_b64_tr_b16 v[58:59], v14 offset:1280
    v_mfma_f32_16x16x32_bf16 v[76:79], v[40:43], v[132:135], v[76:79]
    s_add_u32 m0, s43, 155648
    s_waitcnt lgkmcnt(6)
    v_mfma_f32_16x16x32_bf16 v[88:91], v[44:47], v[128:131], v[88:91]
    ds_read_b64_tr_b16 v[60:61], v14 offset:16640
    ds_read_b64_tr_b16 v[62:63], v14 offset:17664
    v_mfma_f32_16x16x32_bf16 v[92:95], v[44:47], v[132:135], v[92:95]
    buffer_load_dwordx4 v15, s[12:15], s68 offen lds
    s_waitcnt lgkmcnt(6)
    v_mfma_f32_16x16x32_bf16 v[96:99], v[48:51], v[128:131], v[96:99]
    ds_read_b64_tr_b16 v[32:33], v17 offset:8192
    ds_read_b64_tr_b16 v[34:35], v17 offset:9216
    v_mfma_f32_16x16x32_bf16 v[100:103], v[48:51], v[132:135], v[100:103]
    s_waitcnt lgkmcnt(6)
    v_mfma_f32_16x16x32_bf16 v[112:115], v[52:55], v[128:131], v[112:115]
    ds_read_b64_tr_b16 v[36:37], v17 offset:24576
    ds_read_b64_tr_b16 v[38:39], v17 offset:25600
    v_mfma_f32_16x16x32_bf16 v[116:119], v[52:55], v[132:135], v[116:119]
    v_permlane16_swap_b32 v136, v140
    v_permlane16_swap_b32 v137, v141
    v_permlane16_swap_b32 v138, v142
    v_permlane16_swap_b32 v139, v143
    s_waitcnt lgkmcnt(6)
    v_mfma_f32_16x16x32_bf16 v[104:107], v[56:59], v[128:131], v[104:107]
    ds_read_b64_tr_b16 v[40:41], v14 offset:8192
    ds_read_b64_tr_b16 v[42:43], v14 offset:9216
    v_mfma_f32_16x16x32_bf16 v[108:111], v[56:59], v[132:135], v[108:111]
    s_waitcnt lgkmcnt(6)
    v_mfma_f32_16x16x32_bf16 v[120:123], v[60:63], v[128:131], v[120:123]
    ds_read_b64_tr_b16 v[44:45], v14 offset:24576
    ds_read_b64_tr_b16 v[46:47], v14 offset:25600
    v_mfma_f32_16x16x32_bf16 v[124:127], v[60:63], v[132:135], v[124:127]
    s_waitcnt lgkmcnt(6)
    v_mfma_f32_16x16x32_bf16 v[64:67], v[32:35], v[136:139], v[64:67]
    ds_read_b64_tr_b16 v[48:49], v17 offset:8448
    ds_read_b64_tr_b16 v[50:51], v17 offset:9472
    v_mfma_f32_16x16x32_bf16 v[68:71], v[32:35], v[140:143], v[68:71]
    s_waitcnt lgkmcnt(6)
    v_mfma_f32_16x16x32_bf16 v[80:83], v[36:39], v[136:139], v[80:83]
    ds_read_b64_tr_b16 v[52:53], v17 offset:24832
    ds_read_b64_tr_b16 v[54:55], v17 offset:25856
    v_mfma_f32_16x16x32_bf16 v[84:87], v[36:39], v[140:143], v[84:87]
    s_waitcnt lgkmcnt(6)
    v_mfma_f32_16x16x32_bf16 v[72:75], v[40:43], v[136:139], v[72:75]
    ds_read_b64_tr_b16 v[56:57], v14 offset:8448
    ds_read_b64_tr_b16 v[58:59], v14 offset:9472
    v_mfma_f32_16x16x32_bf16 v[76:79], v[40:43], v[140:143], v[76:79]
    s_waitcnt lgkmcnt(6)
    v_mfma_f32_16x16x32_bf16 v[88:91], v[44:47], v[136:139], v[88:91]
    ds_read_b64_tr_b16 v[60:61], v14 offset:24832
    ds_read_b64_tr_b16 v[62:63], v14 offset:25856
    v_mfma_f32_16x16x32_bf16 v[92:95], v[44:47], v[140:143], v[92:95]
    s_waitcnt vmcnt(7)
    s_barrier
    v_add_u32 v10, 65536, v10
    v_add_u32 v11, 65536, v11
    v_add_u32 v12, 65536, v12
    v_add_u32 v13, 65536, v13
    v_add_u32 v16, 65536, v16
    s_add_u32 s68, s39, 3
    s_and_b32 s68, s68, 7
    s_add_u32 m0, s43, 0
    s_mul_i32 s68, s68, 229376
    s_waitcnt lgkmcnt(6)
    v_mfma_f32_16x16x32_bf16 v[96:99], v[48:51], v[136:139], v[96:99]
    ds_read_b128 v[208:211], v10
    ds_read_b64_tr_b16 v[32:33], v16 offset:16384
    ds_read_b64_tr_b16 v[34:35], v16 offset:16896
    v_mfma_f32_16x16x32_bf16 v[100:103], v[48:51], v[140:143], v[100:103]
    buffer_load_dwordx4 v15, s[8:11], s68 offen lds
    s_waitcnt lgkmcnt(7)
    v_mfma_f32_16x16x32_bf16 v[112:115], v[52:55], v[136:139], v[112:115]
    ds_read_b128 v[212:215], v11
    ds_read_b64_tr_b16 v[36:37], v16 offset:18432
    ds_read_b64_tr_b16 v[38:39], v16 offset:18944
    v_mfma_f32_16x16x32_bf16 v[116:119], v[52:55], v[140:143], v[116:119]
    s_waitcnt lgkmcnt(8)
    v_mfma_f32_16x16x32_bf16 v[104:107], v[56:59], v[136:139], v[104:107]
    ds_read_b128 v[216:219], v12
    ds_read_b64_tr_b16 v[40:41], v16 offset:20480
    ds_read_b64_tr_b16 v[42:43], v16 offset:20992
    v_mfma_f32_16x16x32_bf16 v[108:111], v[56:59], v[140:143], v[108:111]
    s_waitcnt lgkmcnt(9)
    v_mfma_f32_16x16x32_bf16 v[120:123], v[60:63], v[136:139], v[120:123]
    ds_read_b128 v[220:223], v13
    ds_read_b64_tr_b16 v[44:45], v16 offset:22528
    ds_read_b64_tr_b16 v[46:47], v16 offset:23040
    v_mfma_f32_16x16x32_bf16 v[124:127], v[60:63], v[140:143], v[124:127]
    s_waitcnt vmcnt(5)
    s_barrier
    v_add_u32 v10, 32768, v10
    v_add_u32 v11, 32768, v11
    v_add_u32 v12, 32768, v12
    v_add_u32 v13, 32768, v13
    v_add_u32 v16, 32768, v16
    s_add_u32 m0, s43, 16384
    s_waitcnt lgkmcnt(9)
    v_mfma_f32_32x32x16_bf16 v[240:255], v[32:35], v[208:211], v[240:255]
    buffer_load_dwordx4 v15, s[12:15], s68 offen lds
    ds_read_b128 v[224:227], v10
    ds_read_b64_tr_b16 v[48:49], v16 offset:16384
    ds_read_b64_tr_b16 v[50:51], v16 offset:16896
    s_add_u32 m0, s43, 8192
    s_add_u32 s68, s68, 114688
    s_waitcnt lgkmcnt(9)
    v_mfma_f32_32x32x16_bf16 v[240:255], v[36:39], v[212:215], v[240:255]
    buffer_load_dwordx4 v15, s[8:11], s68 offen lds
    ds_read_b128 v[228:231], v11
    ds_read_b64_tr_b16 v[52:53], v16 offset:18432
    ds_read_b64_tr_b16 v[54:55], v16 offset:18944
    s_add_u32 m0, s43, 24576
    s_waitcnt lgkmcnt(9)
    v_mfma_f32_32x32x16_bf16 v[240:255], v[40:43], v[216:219], v[240:255]
    buffer_load_dwordx4 v15, s[12:15], s68 offen lds
    ds_read_b128 v[232:235], v12
    ds_read_b64_tr_b16 v[56:57], v16 offset:20480
    ds_read_b64_tr_b16 v[58:59], v16 offset:20992
    s_add_u32 s68, s39, 4
    s_and_b32 s68, s68, 7
    s_add_u32 m0, s43, 32768
    s_mul_i32 s68, s68, 229376
    s_waitcnt lgkmcnt(9)
    v_mfma_f32_32x32x16_bf16 v[240:255], v[44:47], v[220:223], v[240:255]
    buffer_load_dwordx4 v15, s[8:11], s68 offen lds
    ds_read_b128 v[236:239], v13
    ds_read_b64_tr_b16 v[60:61], v16 offset:22528
    ds_read_b64_tr_b16 v[62:63], v16 offset:23040
    s_lshl_b32 s44, s40, 3
    s_and_b32 s45, s38, 1
    s_lshl_b32 s45, s45, 2
    s_add_u32 s44, s44, s45
    s_lshr_b32 s45, s36, 2
    s_lshl_b32 s45, s45, 1
    s_add_u32 s44, s44, s45
    s_lshl_b32 s44, s44, 6
    s_add_u32 s44, s44, s41
    s_lshl_b32 s44, s44, 10
    s_lshr_b32 s56, s38, 1
    s_lshl_b32 s70, s44, s56
    s_mul_i32 s57, s56, 2097152
    s_add_u32 s70, s70, s57
    s_lshl_b32 s57, 65536, s56
    s_add_u32 s71, s70, s57
    s_cmp_eq_u32 s56, 0
    s_cselect_b32 s73, 0x3eb8aa3b, 1.0
    s_waitcnt vmcnt(5)
    s_barrier
    v_add_u32 v17, 98304, v17
    v_xor_b32_e64 v14, 32, v17
    s_add_u32 m0, s43, 49152
    s_waitcnt lgkmcnt(9)
    v_mfma_f32_32x32x16_bf16 v[240:255], v[48:51], v[224:227], v[240:255]
    buffer_load_dwordx4 v15, s[12:15], s68 offen lds
    ds_read_b64_tr_b16 v[32:33], v17 offset:0
    ds_read_b64_tr_b16 v[34:35], v17 offset:1024
    s_add_u32 m0, s43, 40960
    s_add_u32 s68, s68, 114688
    s_waitcnt lgkmcnt(8)
    v_mfma_f32_32x32x16_bf16 v[240:255], v[52:55], v[228:231], v[240:255]
    buffer_load_dwordx4 v15, s[8:11], s68 offen lds
    ds_read_b64_tr_b16 v[36:37], v17 offset:16384
    ds_read_b64_tr_b16 v[38:39], v17 offset:17408
    v_permlane16_swap_b32 v144, v148
    v_permlane16_swap_b32 v145, v149
    v_permlane16_swap_b32 v146, v150
    v_permlane16_swap_b32 v147, v151
    s_add_u32 m0, s43, 57344
    s_waitcnt lgkmcnt(7)
    v_mfma_f32_32x32x16_bf16 v[240:255], v[56:59], v[232:235], v[240:255]
    buffer_load_dwordx4 v15, s[12:15], s68 offen lds
    ds_read_b64_tr_b16 v[40:41], v14 offset:0
    ds_read_b64_tr_b16 v[42:43], v14 offset:1024
    s_add_u32 s68, s39, 5
    s_and_b32 s68, s68, 7
    s_add_u32 m0, s43, 65536
    s_mul_i32 s68, s68, 229376
    s_waitcnt lgkmcnt(6)
    v_mfma_f32_32x32x16_bf16 v[240:255], v[60:63], v[236:239], v[240:255]
    buffer_load_dwordx4 v15, s[8:11], s68 offen lds
    ds_read_b64_tr_b16 v[44:45], v14 offset:16384
    ds_read_b64_tr_b16 v[46:47], v14 offset:17408
    s_waitcnt lgkmcnt(6)
    v_mfma_f32_16x16x32_bf16 v[64:67], v[32:35], v[144:147], v[64:67]
    ds_read_b64_tr_b16 v[48:49], v17 offset:256
    ds_read_b64_tr_b16 v[50:51], v17 offset:1280
    v_mfma_f32_16x16x32_bf16 v[68:71], v[32:35], v[148:151], v[68:71]
    s_waitcnt lgkmcnt(6)
    v_mfma_f32_16x16x32_bf16 v[80:83], v[36:39], v[144:147], v[80:83]
    ds_read_b64_tr_b16 v[52:53], v17 offset:16640
    ds_read_b64_tr_b16 v[54:55], v17 offset:17664
    v_mfma_f32_16x16x32_bf16 v[84:87], v[36:39], v[148:151], v[84:87]
    v_mul_f32 v240, s73, v240
    v_mul_f32 v241, s73, v241
    v_mul_f32 v242, s73, v242
    v_mul_f32 v243, s73, v243
    v_mul_f32 v244, s73, v244
    v_mul_f32 v245, s73, v245
    v_mul_f32 v246, s73, v246
    v_mul_f32_e64 v247, s73, v247
    s_waitcnt lgkmcnt(6)
    v_mfma_f32_16x16x32_bf16 v[72:75], v[40:43], v[144:147], v[72:75]
    ds_read_b64_tr_b16 v[56:57], v14 offset:256
    ds_read_b64_tr_b16 v[58:59], v14 offset:1280
    v_mfma_f32_16x16x32_bf16 v[76:79], v[40:43], v[148:151], v[76:79]
    v_mul_f32 v248, s73, v248
    v_mul_f32 v249, s73, v249
    v_mul_f32 v250, s73, v250
    v_mul_f32 v251, s73, v251
    v_mul_f32 v252, s73, v252
    v_mul_f32 v253, s73, v253
    v_mul_f32 v254, s73, v254
    v_mul_f32 v255, s73, v255
    v_cvt_pk_bf16_f32 v18, v240, v241
    v_cvt_pk_bf16_f32 v19, v242, v243
    v_cvt_pk_bf16_f32 v20, v244, v245
    v_cvt_pk_bf16_f32 v21, v246, v247
    buffer_store_dwordx4 v[18:21], v3, s[16:19], s70 offen sc1
    s_add_u32 m0, s43, 81920
    s_waitcnt lgkmcnt(6)
    v_mfma_f32_16x16x32_bf16 v[88:91], v[44:47], v[144:147], v[88:91]
    ds_read_b64_tr_b16 v[60:61], v14 offset:16640
    ds_read_b64_tr_b16 v[62:63], v14 offset:17664
    v_mfma_f32_16x16x32_bf16 v[92:95], v[44:47], v[148:151], v[92:95]
    buffer_load_dwordx4 v15, s[12:15], s68 offen lds
    v_cvt_pk_bf16_f32 v22, v248, v249
    v_cvt_pk_bf16_f32 v23, v250, v251
    v_cvt_pk_bf16_f32 v24, v252, v253
    v_cvt_pk_bf16_f32 v25, v254, v255
    s_waitcnt lgkmcnt(6)
    v_mfma_f32_16x16x32_bf16 v[96:99], v[48:51], v[144:147], v[96:99]
    ds_read_b64_tr_b16 v[32:33], v17 offset:8192
    ds_read_b64_tr_b16 v[34:35], v17 offset:9216
    v_mfma_f32_16x16x32_bf16 v[100:103], v[48:51], v[148:151], v[100:103]
    s_waitcnt lgkmcnt(6)
    v_mfma_f32_16x16x32_bf16 v[112:115], v[52:55], v[144:147], v[112:115]
    ds_read_b64_tr_b16 v[36:37], v17 offset:24576
    ds_read_b64_tr_b16 v[38:39], v17 offset:25600
    v_mfma_f32_16x16x32_bf16 v[116:119], v[52:55], v[148:151], v[116:119]
    v_permlane16_swap_b32 v152, v156
    v_permlane16_swap_b32 v153, v157
    v_permlane16_swap_b32 v154, v158
    v_permlane16_swap_b32 v155, v159
    s_waitcnt lgkmcnt(6)
    v_mfma_f32_16x16x32_bf16 v[104:107], v[56:59], v[144:147], v[104:107]
    ds_read_b64_tr_b16 v[40:41], v14 offset:8192
    ds_read_b64_tr_b16 v[42:43], v14 offset:9216
    v_mfma_f32_16x16x32_bf16 v[108:111], v[56:59], v[148:151], v[108:111]
    buffer_store_dwordx4 v[22:25], v3, s[16:19], s71 offen sc1
    s_add_u32 m0, s43, 73728
    s_add_u32 s68, s68, 114688
    s_waitcnt lgkmcnt(6)
    v_mfma_f32_16x16x32_bf16 v[120:123], v[60:63], v[144:147], v[120:123]
    ds_read_b64_tr_b16 v[44:45], v14 offset:24576
    ds_read_b64_tr_b16 v[46:47], v14 offset:25600
    v_mfma_f32_16x16x32_bf16 v[124:127], v[60:63], v[148:151], v[124:127]
    buffer_load_dwordx4 v15, s[8:11], s68 offen lds
    s_waitcnt lgkmcnt(6)
    v_mfma_f32_16x16x32_bf16 v[64:67], v[32:35], v[152:155], v[64:67]
    ds_read_b64_tr_b16 v[48:49], v17 offset:8448
    ds_read_b64_tr_b16 v[50:51], v17 offset:9472
    v_mfma_f32_16x16x32_bf16 v[68:71], v[32:35], v[156:159], v[68:71]
    s_waitcnt lgkmcnt(6)
    v_mfma_f32_16x16x32_bf16 v[80:83], v[36:39], v[152:155], v[80:83]
    ds_read_b64_tr_b16 v[52:53], v17 offset:24832
    ds_read_b64_tr_b16 v[54:55], v17 offset:25856
    v_mfma_f32_16x16x32_bf16 v[84:87], v[36:39], v[156:159], v[84:87]
    s_waitcnt lgkmcnt(6)
    v_mfma_f32_16x16x32_bf16 v[72:75], v[40:43], v[152:155], v[72:75]
    ds_read_b64_tr_b16 v[56:57], v14 offset:8448
    ds_read_b64_tr_b16 v[58:59], v14 offset:9472
    v_mfma_f32_16x16x32_bf16 v[76:79], v[40:43], v[156:159], v[76:79]
    s_add_u32 m0, s43, 90112
    s_waitcnt lgkmcnt(6)
    v_mfma_f32_16x16x32_bf16 v[88:91], v[44:47], v[152:155], v[88:91]
    ds_read_b64_tr_b16 v[60:61], v14 offset:24832
    ds_read_b64_tr_b16 v[62:63], v14 offset:25856
    v_mfma_f32_16x16x32_bf16 v[92:95], v[44:47], v[156:159], v[92:95]
    buffer_load_dwordx4 v15, s[12:15], s68 offen lds
    s_waitcnt vmcnt(10)
    s_barrier
    s_mul_i32 s72, s41, 114688
    s_mul_i32 s45, s40, 28672
    s_add_u32 s72, s72, s45
    s_lshl_b32 s45, s38, 13
    s_add_u32 s72, s72, s45
    s_and_b32 s56, s36, 4
    s_lshl_b32 s45, s56, 10
    s_add_u32 s72, s72, s45
    s_add_u32 s72, s72, 8388608
    s_lshl_b32 s70, s41, 12
    s_lshl_b32 s45, s40, 10
    s_add_u32 s70, s70, s45
    s_lshl_b32 s45, s38, 8
    s_add_u32 s70, s70, s45
    s_lshl_b32 s45, s56, 5
    s_add_u32 s70, s70, s45
    s_add_u32 s70, s70, 16252928
    s_mov_b32 s50, 0x0000ffff
    s_mov_b32 s51, 0x0000ffff
    v_add_u32 v17, 4294836224, v17
    v_xor_b32 v14, 32, v17
    s_waitcnt lgkmcnt(6)
    v_mfma_f32_16x16x32_bf16 v[96:99], v[48:51], v[152:155], v[96:99]
    ds_read_b64_tr_b16 v[32:33], v17 offset:0
    ds_read_b64_tr_b16 v[34:35], v17 offset:1024
    v_mfma_f32_16x16x32_bf16 v[100:103], v[48:51], v[156:159], v[100:103]
    s_waitcnt lgkmcnt(6)
    v_mfma_f32_16x16x32_bf16 v[112:115], v[52:55], v[152:155], v[112:115]
    ds_read_b64_tr_b16 v[36:37], v17 offset:16384
    ds_read_b64_tr_b16 v[38:39], v17 offset:17408
    v_mfma_f32_16x16x32_bf16 v[116:119], v[52:55], v[156:159], v[116:119]
    v_permlane16_swap_b32 v160, v164
    v_permlane16_swap_b32 v161, v165
    v_permlane16_swap_b32 v162, v166
    v_permlane16_swap_b32 v163, v167
    s_lshl_b32 s85, s41, 5
    s_lshl_b32 s45, s40, 3
    s_add_u32 s85, s85, s45
    s_lshl_b32 s45, s38, 1
    s_add_u32 s85, s85, s45
    s_lshr_b32 s45, s36, 2
    s_add_u32 s85, s85, s45
    s_lshl_b32 s44, s85, 10
    buffer_load_dwordx4 v[240:243], v3, s[4:7], s44 offen
    buffer_load_dwordx4 v[244:247], v3, s[88:91], 0 offen
    s_waitcnt lgkmcnt(6)
    v_mfma_f32_16x16x32_bf16 v[104:107], v[56:59], v[152:155], v[104:107]
    ds_read_b64_tr_b16 v[40:41], v14 offset:0
    ds_read_b64_tr_b16 v[42:43], v14 offset:1024
    v_mfma_f32_16x16x32_bf16 v[108:111], v[56:59], v[156:159], v[108:111]
    s_add_u32 s68, s39, 6
    s_and_b32 s68, s68, 7
    s_add_u32 m0, s43, 98304
    s_mul_i32 s68, s68, 229376
    s_waitcnt lgkmcnt(6)
    v_mfma_f32_16x16x32_bf16 v[120:123], v[60:63], v[152:155], v[120:123]
    ds_read_b64_tr_b16 v[44:45], v14 offset:16384
    ds_read_b64_tr_b16 v[46:47], v14 offset:17408
    v_mfma_f32_16x16x32_bf16 v[124:127], v[60:63], v[156:159], v[124:127]
    buffer_load_dwordx4 v15, s[8:11], s68 offen lds
    s_waitcnt lgkmcnt(6)
    v_mfma_f32_16x16x32_bf16 v[64:67], v[32:35], v[160:163], v[64:67]
    ds_read_b64_tr_b16 v[48:49], v17 offset:256
    ds_read_b64_tr_b16 v[50:51], v17 offset:1280
    v_mfma_f32_16x16x32_bf16 v[68:71], v[32:35], v[164:167], v[68:71]
    s_waitcnt lgkmcnt(6)
    v_mfma_f32_16x16x32_bf16 v[80:83], v[36:39], v[160:163], v[80:83]
    ds_read_b64_tr_b16 v[52:53], v17 offset:16640
    ds_read_b64_tr_b16 v[54:55], v17 offset:17664
    v_mfma_f32_16x16x32_bf16 v[84:87], v[36:39], v[164:167], v[84:87]
    s_waitcnt lgkmcnt(6)
    v_mfma_f32_16x16x32_bf16 v[72:75], v[40:43], v[160:163], v[72:75]
    ds_read_b64_tr_b16 v[56:57], v14 offset:256
    ds_read_b64_tr_b16 v[58:59], v14 offset:1280
    v_mfma_f32_16x16x32_bf16 v[76:79], v[40:43], v[164:167], v[76:79]
    s_add_u32 m0, s43, 114688
    s_waitcnt lgkmcnt(6)
    v_mfma_f32_16x16x32_bf16 v[88:91], v[44:47], v[160:163], v[88:91]
    ds_read_b64_tr_b16 v[60:61], v14 offset:16640
    ds_read_b64_tr_b16 v[62:63], v14 offset:17664
    v_mfma_f32_16x16x32_bf16 v[92:95], v[44:47], v[164:167], v[92:95]
    buffer_load_dwordx4 v15, s[12:15], s68 offen lds
    s_waitcnt lgkmcnt(6)
    v_mfma_f32_16x16x32_bf16 v[96:99], v[48:51], v[160:163], v[96:99]
    ds_read_b64_tr_b16 v[32:33], v17 offset:8192
    ds_read_b64_tr_b16 v[34:35], v17 offset:9216
    v_mfma_f32_16x16x32_bf16 v[100:103], v[48:51], v[164:167], v[100:103]
    s_waitcnt lgkmcnt(6)
    v_mfma_f32_16x16x32_bf16 v[112:115], v[52:55], v[160:163], v[112:115]
    ds_read_b64_tr_b16 v[36:37], v17 offset:24576
    ds_read_b64_tr_b16 v[38:39], v17 offset:25600
    v_mfma_f32_16x16x32_bf16 v[116:119], v[52:55], v[164:167], v[116:119]
    v_permlane16_swap_b32 v168, v172
    v_permlane16_swap_b32 v169, v173
    v_permlane16_swap_b32 v170, v174
    v_permlane16_swap_b32 v171, v175
    s_waitcnt lgkmcnt(6)
    v_mfma_f32_16x16x32_bf16 v[104:107], v[56:59], v[160:163], v[104:107]
    ds_read_b64_tr_b16 v[40:41], v14 offset:8192
    ds_read_b64_tr_b16 v[42:43], v14 offset:9216
    v_mfma_f32_16x16x32_bf16 v[108:111], v[56:59], v[164:167], v[108:111]
    s_add_u32 m0, s43, 106496
    s_add_u32 s68, s68, 114688
    s_waitcnt lgkmcnt(6)
    v_mfma_f32_16x16x32_bf16 v[120:123], v[60:63], v[160:163], v[120:123]
    ds_read_b64_tr_b16 v[44:45], v14 offset:24576
    ds_read_b64_tr_b16 v[46:47], v14 offset:25600
    v_mfma_f32_16x16x32_bf16 v[124:127], v[60:63], v[164:167], v[124:127]
    buffer_load_dwordx4 v15, s[8:11], s68 offen lds
    s_waitcnt vmcnt(11)
    s_waitcnt vmcnt(7)
    s_barrier
    s_cmp_lg_u32 s36, 7
    s_cbranch_scc1 Lnf_6
    s_lshl_b32 s44, s40, 13
    s_lshl_b32 s45, s38, 11
    s_add_u32 s44, s44, s45
    s_lshl_b32 s45, s37, 7
    s_add_u32 s44, s44, s45
    s_add_u32 s44, s44, 15990784
    v_mov_b32 v18, s54
    v_mov_b32 v19, s55
    v_mov_b32_e64 v20, 0
    s_mov_b64 exec, 1
    buffer_store_dwordx2 v[18:19], v20, s[16:19], s44 offen sc1
    s_mov_b64 exec, -1
Lnf_6:
    s_waitcnt lgkmcnt(6)
    v_mfma_f32_16x16x32_bf16 v[64:67], v[32:35], v[168:171], v[64:67]
    ds_read_b64_tr_b16 v[48:49], v17 offset:8448
    ds_read_b64_tr_b16 v[50:51], v17 offset:9472
    v_mfma_f32_16x16x32_bf16 v[68:71], v[32:35], v[172:175], v[68:71]
    s_waitcnt lgkmcnt(6)
    v_mfma_f32_16x16x32_bf16 v[80:83], v[36:39], v[168:171], v[80:83]
    ds_read_b64_tr_b16 v[52:53], v17 offset:24832
    ds_read_b64_tr_b16 v[54:55], v17 offset:25856
    v_mfma_f32_16x16x32_bf16 v[84:87], v[36:39], v[172:175], v[84:87]
    s_waitcnt lgkmcnt(6)
    v_mfma_f32_16x16x32_bf16 v[72:75], v[40:43], v[168:171], v[72:75]
    ds_read_b64_tr_b16 v[56:57], v14 offset:8448
    ds_read_b64_tr_b16 v[58:59], v14 offset:9472
    v_mfma_f32_16x16x32_bf16 v[76:79], v[40:43], v[172:175], v[76:79]
    s_add_u32 m0, s43, 122880
    s_waitcnt lgkmcnt(6)
    v_mfma_f32_16x16x32_bf16 v[88:91], v[44:47], v[168:171], v[88:91]
    ds_read_b64_tr_b16 v[60:61], v14 offset:24832
    ds_read_b64_tr_b16 v[62:63], v14 offset:25856
    v_mfma_f32_16x16x32_bf16 v[92:95], v[44:47], v[172:175], v[92:95]
    buffer_load_dwordx4 v15, s[12:15], s68 offen lds
    v_add_u32 v17, 32768, v17
    v_xor_b32_e64 v14, 32, v17
    s_waitcnt lgkmcnt(6)
    v_mfma_f32_16x16x32_bf16 v[96:99], v[48:51], v[168:171], v[96:99]
    ds_read_b64_tr_b16 v[32:33], v17 offset:0
    ds_read_b64_tr_b16 v[34:35], v17 offset:1024
    v_mfma_f32_16x16x32_bf16 v[100:103], v[48:51], v[172:175], v[100:103]
    s_waitcnt lgkmcnt(6)
    v_mfma_f32_16x16x32_bf16 v[112:115], v[52:55], v[168:171], v[112:115]
    ds_read_b64_tr_b16 v[36:37], v17 offset:16384
    ds_read_b64_tr_b16 v[38:39], v17 offset:17408
    v_mfma_f32_16x16x32_bf16 v[116:119], v[52:55], v[172:175], v[116:119]
    v_permlane16_swap_b32 v176, v180
    v_permlane16_swap_b32 v177, v181
    v_permlane16_swap_b32 v178, v182
    v_permlane16_swap_b32 v179, v183
    s_waitcnt lgkmcnt(6)
    v_mfma_f32_16x16x32_bf16 v[104:107], v[56:59], v[168:171], v[104:107]
    ds_read_b64_tr_b16 v[40:41], v14 offset:0
    ds_read_b64_tr_b16 v[42:43], v14 offset:1024
    v_mfma_f32_16x16x32_bf16 v[108:111], v[56:59], v[172:175], v[108:111]
    s_add_u32 s68, s39, 7
    s_and_b32 s68, s68, 7
    s_add_u32 m0, s43, 131072
    s_mul_i32 s68, s68, 229376
    s_waitcnt lgkmcnt(6)
    v_mfma_f32_16x16x32_bf16 v[120:123], v[60:63], v[168:171], v[120:123]
    ds_read_b64_tr_b16 v[44:45], v14 offset:16384
    ds_read_b64_tr_b16 v[46:47], v14 offset:17408
    v_mfma_f32_16x16x32_bf16 v[124:127], v[60:63], v[172:175], v[124:127]
    buffer_load_dwordx4 v15, s[8:11], s68 offen lds
    s_waitcnt lgkmcnt(6)
    v_mfma_f32_16x16x32_bf16 v[64:67], v[32:35], v[176:179], v[64:67]
    ds_read_b64_tr_b16 v[48:49], v17 offset:256
    ds_read_b64_tr_b16 v[50:51], v17 offset:1280
    v_mfma_f32_16x16x32_bf16 v[68:71], v[32:35], v[180:183], v[68:71]
    s_waitcnt lgkmcnt(6)
    v_mfma_f32_16x16x32_bf16 v[80:83], v[36:39], v[176:179], v[80:83]
    ds_read_b64_tr_b16 v[52:53], v17 offset:16640
    ds_read_b64_tr_b16 v[54:55], v17 offset:17664
    v_mfma_f32_16x16x32_bf16 v[84:87], v[36:39], v[180:183], v[84:87]
    s_waitcnt lgkmcnt(6)
    v_mfma_f32_16x16x32_bf16 v[72:75], v[40:43], v[176:179], v[72:75]
    ds_read_b64_tr_b16 v[56:57], v14 offset:256
    ds_read_b64_tr_b16 v[58:59], v14 offset:1280
    v_mfma_f32_16x16x32_bf16 v[76:79], v[40:43], v[180:183], v[76:79]
    s_add_u32 m0, s43, 147456
    s_waitcnt lgkmcnt(6)
    v_mfma_f32_16x16x32_bf16 v[88:91], v[44:47], v[176:179], v[88:91]
    ds_read_b64_tr_b16 v[60:61], v14 offset:16640
    ds_read_b64_tr_b16 v[62:63], v14 offset:17664
    v_mfma_f32_16x16x32_bf16 v[92:95], v[44:47], v[180:183], v[92:95]
    buffer_load_dwordx4 v15, s[12:15], s68 offen lds
    s_waitcnt lgkmcnt(6)
    v_mfma_f32_16x16x32_bf16 v[96:99], v[48:51], v[176:179], v[96:99]
    ds_read_b64_tr_b16 v[32:33], v17 offset:8192
    ds_read_b64_tr_b16 v[34:35], v17 offset:9216
    v_mfma_f32_16x16x32_bf16 v[100:103], v[48:51], v[180:183], v[100:103]
    s_waitcnt lgkmcnt(6)
    v_mfma_f32_16x16x32_bf16 v[112:115], v[52:55], v[176:179], v[112:115]
    ds_read_b64_tr_b16 v[36:37], v17 offset:24576
    ds_read_b64_tr_b16 v[38:39], v17 offset:25600
    v_mfma_f32_16x16x32_bf16 v[116:119], v[52:55], v[180:183], v[116:119]
    v_permlane16_swap_b32 v184, v188
    v_permlane16_swap_b32 v185, v189
    v_permlane16_swap_b32 v186, v190
    v_permlane16_swap_b32 v187, v191
    s_waitcnt lgkmcnt(6)
    v_mfma_f32_16x16x32_bf16 v[104:107], v[56:59], v[176:179], v[104:107]
    ds_read_b64_tr_b16 v[40:41], v14 offset:8192
    ds_read_b64_tr_b16 v[42:43], v14 offset:9216
    v_mfma_f32_16x16x32_bf16 v[108:111], v[56:59], v[180:183], v[108:111]
    s_add_u32 m0, s43, 139264
    s_add_u32 s68, s68, 114688
    s_waitcnt lgkmcnt(6)
    v_mfma_f32_16x16x32_bf16 v[120:123], v[60:63], v[176:179], v[120:123]
    ds_read_b64_tr_b16 v[44:45], v14 offset:24576
    ds_read_b64_tr_b16 v[46:47], v14 offset:25600
    v_mfma_f32_16x16x32_bf16 v[124:127], v[60:63], v[180:183], v[124:127]
    buffer_load_dwordx4 v15, s[8:11], s68 offen lds
    s_waitcnt lgkmcnt(6)
    v_mfma_f32_16x16x32_bf16 v[64:67], v[32:35], v[184:187], v[64:67]
    ds_read_b64_tr_b16 v[48:49], v17 offset:8448
    ds_read_b64_tr_b16 v[50:51], v17 offset:9472
    v_mfma_f32_16x16x32_bf16 v[68:71], v[32:35], v[188:191], v[68:71]
    s_waitcnt vmcnt(7)
    v_dot2_f32_bf16 v12, v240, v244, 0
    v_dot2_f32_bf16 v12, v241, v245, v12
    v_dot2_f32_bf16 v12, v242, v246, v12
    v_dot2_f32_bf16 v12, v243, v247, v12
    s_waitcnt lgkmcnt(6)
    v_mfma_f32_16x16x32_bf16 v[80:83], v[36:39], v[184:187], v[80:83]
    ds_read_b64_tr_b16 v[52:53], v17 offset:24832
    ds_read_b64_tr_b16 v[54:55], v17 offset:25856
    v_mfma_f32_16x16x32_bf16 v[84:87], v[36:39], v[188:191], v[84:87]
    v_add_f32_dpp v12, v12, v12 row_shr:1 row_mask:0xf bank_mask:0xf bound_ctrl:0
    s_waitcnt lgkmcnt(6)
    v_mfma_f32_16x16x32_bf16 v[72:75], v[40:43], v[184:187], v[72:75]
    ds_read_b64_tr_b16 v[56:57], v14 offset:8448
    ds_read_b64_tr_b16 v[58:59], v14 offset:9472
    v_mfma_f32_16x16x32_bf16 v[76:79], v[40:43], v[188:191], v[76:79]
    v_add_f32_dpp v12, v12, v12 row_shr:2 row_mask:0xf bank_mask:0xf bound_ctrl:0
    s_add_u32 m0, s43, 155648
    s_waitcnt lgkmcnt(6)
    v_mfma_f32_16x16x32_bf16 v[88:91], v[44:47], v[184:187], v[88:91]
    ds_read_b64_tr_b16 v[60:61], v14 offset:24832
    ds_read_b64_tr_b16 v[62:63], v14 offset:25856
    v_mfma_f32_16x16x32_bf16 v[92:95], v[44:47], v[188:191], v[92:95]
    buffer_load_dwordx4 v15, s[12:15], s68 offen lds
    v_add_f32_dpp v12, v12, v12 row_shr:4 row_mask:0xf bank_mask:0xf bound_ctrl:0
    s_barrier
    v_add_u32 v17, 32768, v17
    v_xor_b32_e64 v14, 32, v17
    s_waitcnt lgkmcnt(6)
    v_mfma_f32_16x16x32_bf16 v[96:99], v[48:51], v[184:187], v[96:99]
    ds_read_b64_tr_b16 v[32:33], v17 offset:0
    ds_read_b64_tr_b16 v[34:35], v17 offset:1024
    v_mfma_f32_16x16x32_bf16 v[100:103], v[48:51], v[188:191], v[100:103]
    v_add_f32_dpp v12, v12, v12 row_shr:8 row_mask:0xf bank_mask:0xf bound_ctrl:0
    s_waitcnt lgkmcnt(6)
    v_mfma_f32_16x16x32_bf16 v[112:115], v[52:55], v[184:187], v[112:115]
    ds_read_b64_tr_b16 v[36:37], v17 offset:16384
    ds_read_b64_tr_b16 v[38:39], v17 offset:17408
    v_mfma_f32_16x16x32_bf16 v[116:119], v[52:55], v[188:191], v[116:119]
    v_permlane16_swap_b32 v192, v196
    v_permlane16_swap_b32 v193, v197
    v_permlane16_swap_b32 v194, v198
    v_permlane16_swap_b32 v195, v199
    v_add_f32_dpp v12, v12, v12 row_bcast:15 row_mask:0xa bank_mask:0xf
    s_waitcnt lgkmcnt(6)
    v_mfma_f32_16x16x32_bf16 v[104:107], v[56:59], v[184:187], v[104:107]
    ds_read_b64_tr_b16 v[40:41], v14 offset:0
    ds_read_b64_tr_b16 v[42:43], v14 offset:1024
    v_mfma_f32_16x16x32_bf16 v[108:111], v[56:59], v[188:191], v[108:111]
    v_add_f32_dpp v12, v12, v12 row_bcast:31 row_mask:0xc bank_mask:0xf
    v_mul_f32 v12, 0xbfb8aa3b, v12
    v_exp_f32 v12, v12
    v_mov_b32_e64 v13, 0
    s_waitcnt lgkmcnt(6)
    v_mfma_f32_16x16x32_bf16 v[120:123], v[60:63], v[184:187], v[120:123]
    ds_read_b64_tr_b16 v[44:45], v14 offset:16384
    ds_read_b64_tr_b16 v[46:47], v14 offset:17408
    v_mfma_f32_16x16x32_bf16 v[124:127], v[60:63], v[188:191], v[124:127]
    v_add_f32 v12, 1.0, v12
    v_rcp_f32_e64 v12, v12
    s_lshl_b32 s44, s85, 7
    s_add_u32 s85, s44, 15728640
    s_waitcnt lgkmcnt(6)
    v_mfma_f32_16x16x32_bf16 v[64:67], v[32:35], v[192:195], v[64:67]
    ds_read_b64_tr_b16 v[48:49], v17 offset:256
    ds_read_b64_tr_b16 v[50:51], v17 offset:1280
    v_mfma_f32_16x16x32_bf16 v[68:71], v[32:35], v[196:199], v[68:71]
    s_mov_b32 exec_lo, 0
    s_brev_b32 exec_hi, 1
    buffer_store_dword v12, v13, s[16:19], s85 offen sc1
    s_mov_b64 exec, -1
    s_waitcnt lgkmcnt(6)
    v_mfma_f32_16x16x32_bf16 v[80:83], v[36:39], v[192:195], v[80:83]
    ds_read_b64_tr_b16 v[52:53], v17 offset:16640
    ds_read_b64_tr_b16 v[54:55], v17 offset:17664
    v_mfma_f32_16x16x32_bf16 v[84:87], v[36:39], v[196:199], v[84:87]
    s_waitcnt lgkmcnt(6)
    v_mfma_f32_16x16x32_bf16 v[72:75], v[40:43], v[192:195], v[72:75]
    ds_read_b64_tr_b16 v[56:57], v14 offset:256
    ds_read_b64_tr_b16 v[58:59], v14 offset:1280
    v_mfma_f32_16x16x32_bf16 v[76:79], v[40:43], v[196:199], v[76:79]
    s_waitcnt lgkmcnt(6)
    v_mfma_f32_16x16x32_bf16 v[88:91], v[44:47], v[192:195], v[88:91]
    ds_read_b64_tr_b16 v[60:61], v14 offset:16640
    ds_read_b64_tr_b16 v[62:63], v14 offset:17664
    v_mfma_f32_16x16x32_bf16 v[92:95], v[44:47], v[196:199], v[92:95]
    s_waitcnt lgkmcnt(6)
    v_mfma_f32_16x16x32_bf16 v[96:99], v[48:51], v[192:195], v[96:99]
    ds_read_b64_tr_b16 v[32:33], v17 offset:8192
    ds_read_b64_tr_b16 v[34:35], v17 offset:9216
    v_mfma_f32_16x16x32_bf16 v[100:103], v[48:51], v[196:199], v[100:103]
    s_waitcnt lgkmcnt(6)
    v_mfma_f32_16x16x32_bf16 v[112:115], v[52:55], v[192:195], v[112:115]
    ds_read_b64_tr_b16 v[36:37], v17 offset:24576
    ds_read_b64_tr_b16 v[38:39], v17 offset:25600
    v_mfma_f32_16x16x32_bf16 v[116:119], v[52:55], v[196:199], v[116:119]
    v_permlane16_swap_b32 v200, v204
    v_permlane16_swap_b32 v201, v205
    v_permlane16_swap_b32 v202, v206
    v_permlane16_swap_b32 v203, v207
    s_waitcnt lgkmcnt(6)
    v_mfma_f32_16x16x32_bf16 v[104:107], v[56:59], v[192:195], v[104:107]
    ds_read_b64_tr_b16 v[40:41], v14 offset:8192
    ds_read_b64_tr_b16 v[42:43], v14 offset:9216
    v_mfma_f32_16x16x32_bf16 v[108:111], v[56:59], v[196:199], v[108:111]
    s_waitcnt lgkmcnt(6)
    v_mfma_f32_16x16x32_bf16 v[120:123], v[60:63], v[192:195], v[120:123]
    ds_read_b64_tr_b16 v[44:45], v14 offset:24576
    ds_read_b64_tr_b16 v[46:47], v14 offset:25600
    v_mfma_f32_16x16x32_bf16 v[124:127], v[60:63], v[196:199], v[124:127]
    s_waitcnt lgkmcnt(6)
    v_mfma_f32_16x16x32_bf16 v[64:67], v[32:35], v[200:203], v[64:67]
    ds_read_b64_tr_b16 v[48:49], v17 offset:8448
    ds_read_b64_tr_b16 v[50:51], v17 offset:9472
    v_mfma_f32_16x16x32_bf16 v[68:71], v[32:35], v[204:207], v[68:71]
    s_waitcnt lgkmcnt(6)
    v_mfma_f32_16x16x32_bf16 v[80:83], v[36:39], v[200:203], v[80:83]
    ds_read_b64_tr_b16 v[52:53], v17 offset:24832
    ds_read_b64_tr_b16 v[54:55], v17 offset:25856
    v_mfma_f32_16x16x32_bf16 v[84:87], v[36:39], v[204:207], v[84:87]
    s_waitcnt lgkmcnt(6)
    v_mfma_f32_16x16x32_bf16 v[72:75], v[40:43], v[200:203], v[72:75]
    ds_read_b64_tr_b16 v[56:57], v14 offset:8448
    ds_read_b64_tr_b16 v[58:59], v14 offset:9472
    v_mfma_f32_16x16x32_bf16 v[76:79], v[40:43], v[204:207], v[76:79]
    s_waitcnt lgkmcnt(6)
    v_mfma_f32_16x16x32_bf16 v[88:91], v[44:47], v[200:203], v[88:91]
    ds_read_b64_tr_b16 v[60:61], v14 offset:24832
    ds_read_b64_tr_b16 v[62:63], v14 offset:25856
    v_mfma_f32_16x16x32_bf16 v[92:95], v[44:47], v[204:207], v[92:95]
    s_waitcnt vmcnt(5)
    s_barrier
    v_add_u32 v17, 32768, v17
    v_xor_b32_e64 v14, 32, v17
    s_waitcnt lgkmcnt(6)
    v_mfma_f32_16x16x32_bf16 v[96:99], v[48:51], v[200:203], v[96:99]
    ds_read_b64_tr_b16 v[32:33], v17 offset:0
    ds_read_b64_tr_b16 v[34:35], v17 offset:1024
    v_mfma_f32_16x16x32_bf16 v[100:103], v[48:51], v[204:207], v[100:103]
    s_waitcnt lgkmcnt(6)
    v_mfma_f32_16x16x32_bf16 v[112:115], v[52:55], v[200:203], v[112:115]
    ds_read_b64_tr_b16 v[36:37], v17 offset:16384
    ds_read_b64_tr_b16 v[38:39], v17 offset:17408
    v_mfma_f32_16x16x32_bf16 v[116:119], v[52:55], v[204:207], v[116:119]
    v_permlane16_swap_b32 v208, v212
    v_permlane16_swap_b32 v209, v213
    v_permlane16_swap_b32 v210, v214
    v_permlane16_swap_b32 v211, v215
    s_waitcnt lgkmcnt(6)
    v_mfma_f32_16x16x32_bf16 v[104:107], v[56:59], v[200:203], v[104:107]
    ds_read_b64_tr_b16 v[40:41], v14 offset:0
    ds_read_b64_tr_b16 v[42:43], v14 offset:1024
    v_mfma_f32_16x16x32_bf16 v[108:111], v[56:59], v[204:207], v[108:111]
    s_waitcnt lgkmcnt(6)
    v_mfma_f32_16x16x32_bf16 v[120:123], v[60:63], v[200:203], v[120:123]
    ds_read_b64_tr_b16 v[44:45], v14 offset:16384
    ds_read_b64_tr_b16 v[46:47], v14 offset:17408
    v_mfma_f32_16x16x32_bf16 v[124:127], v[60:63], v[204:207], v[124:127]
    s_waitcnt lgkmcnt(6)
    v_mfma_f32_16x16x32_bf16 v[64:67], v[32:35], v[208:211], v[64:67]
    ds_read_b64_tr_b16 v[48:49], v17 offset:256
    ds_read_b64_tr_b16 v[50:51], v17 offset:1280
    v_mfma_f32_16x16x32_bf16 v[68:71], v[32:35], v[212:215], v[68:71]
    s_waitcnt lgkmcnt(6)
    v_mfma_f32_16x16x32_bf16 v[80:83], v[36:39], v[208:211], v[80:83]
    ds_read_b64_tr_b16 v[52:53], v17 offset:16640
    ds_read_b64_tr_b16 v[54:55], v17 offset:17664
    v_mfma_f32_16x16x32_bf16 v[84:87], v[36:39], v[212:215], v[84:87]
    s_waitcnt lgkmcnt(6)
    v_mfma_f32_16x16x32_bf16 v[72:75], v[40:43], v[208:211], v[72:75]
    ds_read_b64_tr_b16 v[56:57], v14 offset:256
    ds_read_b64_tr_b16 v[58:59], v14 offset:1280
    v_mfma_f32_16x16x32_bf16 v[76:79], v[40:43], v[212:215], v[76:79]
    s_waitcnt lgkmcnt(6)
    v_mfma_f32_16x16x32_bf16 v[88:91], v[44:47], v[208:211], v[88:91]
    ds_read_b64_tr_b16 v[60:61], v14 offset:16640
    ds_read_b64_tr_b16 v[62:63], v14 offset:17664
    v_mfma_f32_16x16x32_bf16 v[92:95], v[44:47], v[212:215], v[92:95]
    s_lshr_b32 s82, s46, 3
    s_lshl_b32 s82, s82, 13
    s_add_u32 s82, s82, 15990784
    s_bfe_u32 s45, s46, 0x10002
    s_lshl_b32 s45, s45, 11
    s_lshr_b32 s44, s47, 2
    s_lshl_b32 s44, s44, 7
    s_add_u32 s44, s44, s45
    v_lshlrev_b32_e64 v21, 7, v2
    v_or_b32 v21, s45, v21
    v_add_u32 v21, 4096, v21
    s_mov_b32 exec_lo, 0
    v_mov_b32_e64 v21, s44
    s_mov_b32 exec_lo, -1
    buffer_load_dwordx2 v[26:27], v21, s[16:19], s82 offen sc1
    s_waitcnt lgkmcnt(6)
    v_mfma_f32_16x16x32_bf16 v[96:99], v[48:51], v[208:211], v[96:99]
    ds_read_b64_tr_b16 v[32:33], v17 offset:8192
    ds_read_b64_tr_b16 v[34:35], v17 offset:9216
    v_mfma_f32_16x16x32_bf16 v[100:103], v[48:51], v[212:215], v[100:103]
    s_waitcnt lgkmcnt(6)
    v_mfma_f32_16x16x32_bf16 v[112:115], v[52:55], v[208:211], v[112:115]
    ds_read_b64_tr_b16 v[36:37], v17 offset:24576
    ds_read_b64_tr_b16 v[38:39], v17 offset:25600
    v_mfma_f32_16x16x32_bf16 v[116:119], v[52:55], v[212:215], v[116:119]
    v_permlane16_swap_b32 v216, v220
    v_permlane16_swap_b32 v217, v221
    v_permlane16_swap_b32 v218, v222
    v_permlane16_swap_b32 v219, v223
    s_waitcnt lgkmcnt(6)
    v_mfma_f32_16x16x32_bf16 v[104:107], v[56:59], v[208:211], v[104:107]
    ds_read_b64_tr_b16 v[40:41], v14 offset:8192
    ds_read_b64_tr_b16 v[42:43], v14 offset:9216
    v_mfma_f32_16x16x32_bf16 v[108:111], v[56:59], v[212:215], v[108:111]
    s_waitcnt lgkmcnt(6)
    v_mfma_f32_16x16x32_bf16 v[120:123], v[60:63], v[208:211], v[120:123]
    ds_read_b64_tr_b16 v[44:45], v14 offset:24576
    ds_read_b64_tr_b16 v[46:47], v14 offset:25600
    v_mfma_f32_16x16x32_bf16 v[124:127], v[60:63], v[212:215], v[124:127]
    s_waitcnt vmcnt(2)
    s_barrier
    s_waitcnt lgkmcnt(6)
    v_mfma_f32_16x16x32_bf16 v[64:67], v[32:35], v[216:219], v[64:67]
    ds_read_b64_tr_b16 v[48:49], v17 offset:8448
    ds_read_b64_tr_b16 v[50:51], v17 offset:9472
    v_mfma_f32_16x16x32_bf16 v[68:71], v[32:35], v[220:223], v[68:71]
    s_waitcnt lgkmcnt(6)
    v_mfma_f32_16x16x32_bf16 v[80:83], v[36:39], v[216:219], v[80:83]
    ds_read_b64_tr_b16 v[52:53], v17 offset:24832
    ds_read_b64_tr_b16 v[54:55], v17 offset:25856
    v_mfma_f32_16x16x32_bf16 v[84:87], v[36:39], v[220:223], v[84:87]
    s_waitcnt lgkmcnt(6)
    v_mfma_f32_16x16x32_bf16 v[72:75], v[40:43], v[216:219], v[72:75]
    ds_read_b64_tr_b16 v[56:57], v14 offset:8448
    ds_read_b64_tr_b16 v[58:59], v14 offset:9472
    v_mfma_f32_16x16x32_bf16 v[76:79], v[40:43], v[220:223], v[76:79]
    s_waitcnt lgkmcnt(6)
    v_mfma_f32_16x16x32_bf16 v[88:91], v[44:47], v[216:219], v[88:91]
    ds_read_b64_tr_b16 v[60:61], v14 offset:24832
    ds_read_b64_tr_b16 v[62:63], v14 offset:25856
    v_mfma_f32_16x16x32_bf16 v[92:95], v[44:47], v[220:223], v[92:95]
    s_waitcnt vmcnt(0)
    s_mov_b32 s58, 0x40000
Lchk_7:
    v_cmp_eq_u64 vcc, s[54:55], v[26:27]
    s_cmp_eq_u64 vcc, exec
    s_cbranch_scc0 Lrt_8
Lok_9:
    s_lshl_b32 s44, s46, 16
    s_lshl_b32 s45, s47, 10
    s_add_u32 s44, s44, s45
    buffer_load_dwordx4 v[4:7], v3, s[16:19], s44 offen sc1
    s_add_u32 s44, s59, s81
    buffer_load_dwordx4 v[26:29], v3, s[16:19], s44 offen sc1
    v_add_u32 v17, 32768, v17
    v_xor_b32 v14, 32, v17
    s_lshl_b32 s68, s43, 1
    s_add_u32 m0, s68, 0
    s_add_u32 s68, s81, 0
    s_and_b32 s68, s68, 0x1ffff
    s_add_u32 s68, s68, s59
    s_waitcnt lgkmcnt(6)
    v_mfma_f32_16x16x32_bf16 v[96:99], v[48:51], v[216:219], v[96:99]
    ds_read_b64_tr_b16 v[32:33], v17 offset:0
    ds_read_b64_tr_b16 v[34:35], v17 offset:1024
    v_mfma_f32_16x16x32_bf16 v[100:103], v[48:51], v[220:223], v[100:103]
    buffer_load_dwordx4 v30, s[16:19], s68 offen offset:0 sc1 lds
    v_lshrrev_b32 v18, 5, v2
    v_lshlrev_b32 v10, 12, v18
    v_bfe_u32 v19, v2, 2, 2
    v_lshl_add_u32 v10, v19, 10, v10
    s_waitcnt lgkmcnt(6)
    v_mfma_f32_16x16x32_bf16 v[112:115], v[52:55], v[216:219], v[112:115]
    ds_read_b64_tr_b16 v[36:37], v17 offset:16384
    ds_read_b64_tr_b16 v[38:39], v17 offset:17408
    v_mfma_f32_16x16x32_bf16 v[116:119], v[52:55], v[220:223], v[116:119]
    buffer_load_dwordx4 v30, s[16:19], s68 offen offset:1024 sc1 lds
    v_permlane16_swap_b32 v224, v228
    v_permlane16_swap_b32 v225, v229
    v_permlane16_swap_b32 v226, v230
    v_permlane16_swap_b32 v227, v231
    v_bfe_u32 v20, v2, 4, 1
    v_lshl_add_u32 v10, v20, 6, v10
    v_and_b32 v21, 3, v2
    v_lshl_add_u32 v10, v21, 4, v10
    s_lshl_b32 s44, s49, 7
    v_add_u32_e64 v10, s44, v10
    s_lshl_b32 s68, s43, 1
    s_add_u32 m0, s68, 16384
    s_add_u32 s68, s81, 16384
    s_and_b32 s68, s68, 0x1ffff
    s_add_u32 s68, s68, s59
    s_waitcnt lgkmcnt(6)
    v_mfma_f32_16x16x32_bf16 v[104:107], v[56:59], v[216:219], v[104:107]
    ds_read_b64_tr_b16 v[40:41], v14 offset:0
    ds_read_b64_tr_b16 v[42:43], v14 offset:1024
    v_mfma_f32_16x16x32_bf16 v[108:111], v[56:59], v[220:223], v[108:111]
    buffer_load_dwordx4 v30, s[16:19], s68 offen offset:0 sc1 lds
    v_lshlrev_b32_e64 v22, 6, v19
    v_lshl_add_u32 v22, v20, 5, v22
    v_and_b32_e64 v21, 1, v2
    v_lshl_add_u32 v22, v21, 4, v22
    v_bfe_u32 v23, v2, 1, 1
    v_lshl_add_u32 v22, v23, 3, v22
    s_waitcnt lgkmcnt(6)
    v_mfma_f32_16x16x32_bf16 v[120:123], v[60:63], v[216:219], v[120:123]
    ds_read_b64_tr_b16 v[44:45], v14 offset:16384
    ds_read_b64_tr_b16 v[46:47], v14 offset:17408
    v_mfma_f32_16x16x32_bf16 v[124:127], v[60:63], v[220:223], v[124:127]
    buffer_load_dwordx4 v30, s[16:19], s68 offen offset:1024 sc1 lds
    v_lshl_add_u32 v22, v18, 9, v22
    s_lshl_b32 s68, s43, 1
    s_add_u32 m0, s68, 32768
    s_add_u32 s68, s81, 32768
    s_and_b32 s68, s68, 0x1ffff
    s_add_u32 s68, s68, s59
    s_waitcnt lgkmcnt(6)
    v_mfma_f32_16x16x32_bf16 v[64:67], v[32:35], v[224:227], v[64:67]
    ds_read_b64_tr_b16 v[48:49], v17 offset:256
    ds_read_b64_tr_b16 v[50:51], v17 offset:1280
    v_mfma_f32_16x16x32_bf16 v[68:71], v[32:35], v[228:231], v[68:71]
    buffer_load_dwordx4 v30, s[16:19], s68 offen offset:0 sc1 lds
    s_and_b32 s44, s36, 2
    s_lshl_b32 s44, s44, 4
    s_and_b32 s45, s36, 4
    s_lshl_b32 s45, s45, 6
    s_or_b32 s44, s44, s45
    v_xor_b32_e64 v22, s44, v22
    s_lshl_b32 s42, s36, 12
    s_add_u32 s42, s42, 131072
    v_add_u32_e64 v11, s42, v22
    v_xor_b32 v15, 256, v11
    s_waitcnt lgkmcnt(6)
    v_mfma_f32_16x16x32_bf16 v[80:83], v[36:39], v[224:227], v[80:83]
    ds_read_b64_tr_b16 v[52:53], v17 offset:16640
    ds_read_b64_tr_b16 v[54:55], v17 offset:17664
    v_mfma_f32_16x16x32_bf16 v[84:87], v[36:39], v[228:231], v[84:87]
    buffer_load_dwordx4 v30, s[16:19], s68 offen offset:1024 sc1 lds
    s_and_b32 s44, s36, 1
    s_lshl_b32 s45, s48, 1
    s_add_u32 s75, s44, s45
    v_lshlrev_b32_e64 v21, 12, v21
    v_bfe_u32 v22, v2, 1, 3
    v_lshl_add_u32 v21, v22, 7, v21
    s_waitcnt lgkmcnt(6)
    v_mfma_f32_16x16x32_bf16 v[72:75], v[40:43], v[224:227], v[72:75]
    ds_read_b64_tr_b16 v[56:57], v14 offset:256
    ds_read_b64_tr_b16 v[58:59], v14 offset:1280
    v_mfma_f32_16x16x32_bf16 v[76:79], v[40:43], v[228:231], v[76:79]
    s_lshl_b32 s80, s48, 13
    s_lshr_b32 s52, s36, 1
    s_lshl_b32 s44, s52, 10
    s_add_u32 s80, s80, s44
    s_add_u32 s80, s80, 16252928
    v_and_b32 v24, 15, v2
    v_lshl_add_u32 v24, v20, 5, v24
    v_lshl_add_u32 v24, v18, 4, v24
    v_lshlrev_b32 v24, 4, v24
    s_waitcnt lgkmcnt(6)
    v_mfma_f32_16x16x32_bf16 v[88:91], v[44:47], v[224:227], v[88:91]
    ds_read_b64_tr_b16 v[60:61], v14 offset:16640
    ds_read_b64_tr_b16 v[62:63], v14 offset:17664
    v_mfma_f32_16x16x32_bf16 v[92:95], v[44:47], v[228:231], v[92:95]
    s_cmp_lg_u32 s38, 3
    s_cselect_b64 s[86:87], -1, 0
    s_barrier
    s_waitcnt lgkmcnt(6)
    v_mfma_f32_16x16x32_bf16 v[96:99], v[48:51], v[224:227], v[96:99]
    ds_read_b64_tr_b16 v[32:33], v17 offset:8192
    ds_read_b64_tr_b16 v[34:35], v17 offset:9216
    v_mfma_f32_16x16x32_bf16 v[100:103], v[48:51], v[228:231], v[100:103]
    s_waitcnt vmcnt(6)
    v_mfma_f32_32x32x16_bf16 v[144:159], v[26:29], v[4:7], 0
    s_waitcnt lgkmcnt(6)
    v_mfma_f32_16x16x32_bf16 v[112:115], v[52:55], v[224:227], v[112:115]
    ds_read_b64_tr_b16 v[36:37], v17 offset:24576
    ds_read_b64_tr_b16 v[38:39], v17 offset:25600
    v_mfma_f32_16x16x32_bf16 v[116:119], v[52:55], v[228:231], v[116:119]
    v_permlane16_swap_b32 v232, v236
    v_permlane16_swap_b32 v233, v237
    v_permlane16_swap_b32 v234, v238
    v_permlane16_swap_b32 v235, v239
    v_mov_b32 v220, 0
    v_mov_b32 v221, 0
    v_mov_b32 v222, 0
    v_mov_b32 v223, 0
    v_and_b32 v18, 27, v2
    v_cmp_eq_u32 vcc, 16, v18
    v_mov_b32 v18, 0x3f803f80
    s_waitcnt lgkmcnt(6)
    v_mfma_f32_16x16x32_bf16 v[104:107], v[56:59], v[224:227], v[104:107]
    ds_read_b64_tr_b16 v[40:41], v14 offset:8192
    ds_read_b64_tr_b16 v[42:43], v14 offset:9216
    v_mfma_f32_16x16x32_bf16 v[108:111], v[56:59], v[228:231], v[108:111]
    v_max3_f32 v12, v144, v145, v146
    v_max3_f32 v12, v12, v147, v148
    v_max3_f32 v12, v12, v149, v150
    v_max3_f32 v12, v12, v151, v152
    v_max3_f32 v12, v12, v153, v154
    s_waitcnt lgkmcnt(6)
    v_mfma_f32_16x16x32_bf16 v[120:123], v[60:63], v[224:227], v[120:123]
    ds_read_b64_tr_b16 v[44:45], v14 offset:24576
    ds_read_b64_tr_b16 v[46:47], v14 offset:25600
    v_mfma_f32_16x16x32_bf16 v[124:127], v[60:63], v[228:231], v[124:127]
    v_max3_f32 v12, v12, v155, v156
    v_max3_f32 v12, v12, v157, v158
    v_max_f32 v12, v12, v159
    v_mov_b32_e64 v13, v12
    s_nop 1
    v_permlane32_swap_b32 v12, v13
    s_waitcnt lgkmcnt(6)
    v_mfma_f32_16x16x32_bf16 v[64:67], v[32:35], v[232:235], v[64:67]
    ds_read_b64_tr_b16 v[48:49], v17 offset:8448
    ds_read_b64_tr_b16 v[50:51], v17 offset:9472
    v_mfma_f32_16x16x32_bf16 v[68:71], v[32:35], v[236:239], v[68:71]
    v_max_f32 v12, v12, v13
    v_sub_f32 v128, 0, v12
    v_sub_f32 v129, 0, v12
    v_sub_f32 v130, 0, v12
    v_sub_f32 v131, 0, v12
    v_sub_f32_e64 v132, 0, v12
    s_waitcnt lgkmcnt(6)
    v_mfma_f32_16x16x32_bf16 v[80:83], v[36:39], v[232:235], v[80:83]
    ds_read_b64_tr_b16 v[52:53], v17 offset:24832
    ds_read_b64_tr_b16 v[54:55], v17 offset:25856
    v_mfma_f32_16x16x32_bf16 v[84:87], v[36:39], v[236:239], v[84:87]
    v_sub_f32 v133, 0, v12
    v_sub_f32 v134, 0, v12
    v_sub_f32 v135, 0, v12
    v_sub_f32 v136, 0, v12
    v_sub_f32 v137, 0, v12
    v_sub_f32_e64 v138, 0, v12
    s_waitcnt lgkmcnt(6)
    v_mfma_f32_16x16x32_bf16 v[72:75], v[40:43], v[232:235], v[72:75]
    ds_read_b64_tr_b16 v[56:57], v14 offset:8448
    ds_read_b64_tr_b16 v[58:59], v14 offset:9472
    v_mfma_f32_16x16x32_bf16 v[76:79], v[40:43], v[236:239], v[76:79]
    v_sub_f32 v139, 0, v12
    v_sub_f32 v140, 0, v12
    v_sub_f32 v141, 0, v12
    v_sub_f32 v142, 0, v12
    v_sub_f32 v143, 0, v12
    s_waitcnt lgkmcnt(6)
    v_mfma_f32_16x16x32_bf16 v[88:91], v[44:47], v[232:235], v[88:91]
    ds_read_b64_tr_b16 v[60:61], v14 offset:24832
    ds_read_b64_tr_b16 v[62:63], v14 offset:25856
    v_mfma_f32_16x16x32_bf16 v[92:95], v[44:47], v[236:239], v[92:95]
    v_cndmask_b32 v200, v220, v18, vcc
    v_cndmask_b32 v201, v220, v18, vcc
    v_cndmask_b32 v202, v220, v18, vcc
    v_cndmask_b32 v203, v220, v18, vcc
    v_mfma_f32_32x32x16_bf16 v[144:159], v[26:29], v[4:7], v[128:143]
    s_waitcnt lgkmcnt(6)
    v_mfma_f32_16x16x32_bf16 v[96:99], v[48:51], v[232:235], v[96:99]
    v_mfma_f32_16x16x32_bf16 v[100:103], v[48:51], v[236:239], v[100:103]
    v_cndmask_b32 v204, v220, v18, vcc
    v_cndmask_b32 v205, v220, v18, vcc
    v_cndmask_b32 v206, v220, v18, vcc
    v_cndmask_b32 v207, v220, v18, vcc
    v_mov_b32_e64 v8, v3
    s_waitcnt lgkmcnt(4)
    v_mfma_f32_16x16x32_bf16 v[112:115], v[52:55], v[232:235], v[112:115]
    v_mfma_f32_16x16x32_bf16 v[116:119], v[52:55], v[236:239], v[116:119]
    v_lshrrev_b32 v19, 5, v2
    v_lshlrev_b32 v9, 8, v19
    v_and_b32_e64 v19, 15, v2
    v_lshl_add_u32 v9, v19, 4, v9
    v_add_u32 v9, 1024, v9
    s_waitcnt lgkmcnt(0)
    s_waitcnt vmcnt(2)
    s_barrier
    v_mfma_f32_16x16x32_bf16 v[104:107], v[56:59], v[232:235], v[104:107]
    ds_read_b128 v[196:199], v3 offset:2048
    v_mfma_f32_16x16x32_bf16 v[108:111], v[56:59], v[236:239], v[108:111]
    v_cndmask_b32 v208, v220, v18, vcc
    v_cndmask_b32 v209, v220, v18, vcc
    v_cndmask_b32 v210, v220, v18, vcc
    v_cndmask_b32 v211, v220, v18, vcc
    v_mfma_f32_16x16x32_bf16 v[120:123], v[60:63], v[232:235], v[120:123]
    v_mfma_f32_16x16x32_bf16 v[124:127], v[60:63], v[236:239], v[124:127]
    v_cndmask_b32 v212, v220, v18, vcc
    v_cndmask_b32 v213, v220, v18, vcc
    v_cndmask_b32 v214, v220, v18, vcc
    v_cndmask_b32 v215, v220, v18, vcc
    s_mov_b64 exec, s[50:51]
    ds_read_b128 v[200:203], v9
    ds_read_b128 v[204:207], v9 offset:512
    s_mov_b64 exec, -1
    s_nop 0
    v_pk_mul_f32 v[64:65], v[64:65], v[80:81]
    v_pk_mul_f32 v[66:67], v[66:67], v[82:83]
    v_pk_mul_f32 v[68:69], v[68:69], v[84:85]
    v_pk_mul_f32 v[70:71], v[70:71], v[86:87]
    v_cvt_pk_bf16_f32 v32, v64, v65
    v_cvt_pk_bf16_f32 v33, v66, v67
    v_cvt_pk_bf16_f32 v34, v68, v69
    v_cvt_pk_bf16_f32 v35, v70, v71
    s_nop 1
    v_permlane32_swap_b32 v32, v34
    v_permlane32_swap_b32 v33, v35
    v_pk_mul_f32 v[72:73], v[72:73], v[88:89]
    v_pk_mul_f32 v[74:75], v[74:75], v[90:91]
    v_pk_mul_f32 v[76:77], v[76:77], v[92:93]
    v_pk_mul_f32 v[78:79], v[78:79], v[94:95]
    v_cvt_pk_bf16_f32 v36, v72, v73
    v_cvt_pk_bf16_f32 v37, v74, v75
    v_cvt_pk_bf16_f32 v38, v76, v77
    v_cvt_pk_bf16_f32 v39, v78, v79
    s_nop 1
    v_permlane32_swap_b32 v36, v38
    v_permlane32_swap_b32 v37, v39
    v_pk_mul_f32 v[96:97], v[96:97], v[112:113]
    v_pk_mul_f32 v[98:99], v[98:99], v[114:115]
    v_pk_mul_f32 v[100:101], v[100:101], v[116:117]
    v_pk_mul_f32 v[102:103], v[102:103], v[118:119]
    v_cvt_pk_bf16_f32 v40, v96, v97
    v_cvt_pk_bf16_f32 v41, v98, v99
    v_cvt_pk_bf16_f32 v42, v100, v101
    v_cvt_pk_bf16_f32 v43, v102, v103
    s_nop 1
    v_permlane32_swap_b32 v40, v42
    v_permlane32_swap_b32 v41, v43
    v_pk_mul_f32 v[104:105], v[104:105], v[120:121]
    v_pk_mul_f32 v[106:107], v[106:107], v[122:123]
    v_pk_mul_f32 v[108:109], v[108:109], v[124:125]
    v_pk_mul_f32 v[110:111], v[110:111], v[126:127]
    v_cvt_pk_bf16_f32 v44, v104, v105
    v_cvt_pk_bf16_f32 v45, v106, v107
    v_cvt_pk_bf16_f32 v46, v108, v109
    v_cvt_pk_bf16_f32 v47, v110, v111
    s_nop 1
    v_permlane32_swap_b32 v44, v46
    v_permlane32_swap_b32 v45, v47
    s_branch L_att
L_R:
    s_and_b32 s44, s36, 2
    s_lshl_b32 s44, s44, 4
    v_xor_b32 v15, s44, v15
    s_add_u32 s68, s39, 1
    s_and_b32 s68, s68, 7
    s_add_u32 m0, s43, 65536
    s_mul_i32 s68, s68, 128
    buffer_load_dwordx4 v8, s[4:7], s68 offen lds
    s_add_u32 m0, s43, 73728
    s_add_u32 s68, s68, 65536
    buffer_load_dwordx4 v8, s[4:7], s68 offen lds
    s_add_u32 s68, s39, 1
    s_and_b32 s68, s68, 7
    s_add_u32 m0, s43, 81920
    s_mul_i32 s68, s68, 196608
    buffer_load_dwordx4 v14, s[76:79], s68 offen lds
    s_add_u32 m0, s43, 90112
    s_add_u32 s68, s68, 98304
    buffer_load_dwordx4 v14, s[76:79], s68 offen lds
    s_waitcnt vmcnt(4)
    s_barrier
    ds_read_b128 v[128:131], v10
    ds_read_b64_tr_b16 v[32:33], v17 offset:16384
    ds_read_b64_tr_b16 v[34:35], v17 offset:17408
    ds_read_b64_tr_b16 v[36:37], v17 offset:16640
    ds_read_b64_tr_b16 v[38:39], v17 offset:17664
    ds_read_b128 v[132:135], v11
    ds_read_b64_tr_b16 v[40:41], v17 offset:20480
    ds_read_b64_tr_b16 v[42:43], v17 offset:21504
    ds_read_b64_tr_b16 v[44:45], v17 offset:20736
    ds_read_b64_tr_b16 v[46:47], v17 offset:21760
    s_add_u32 s68, s39, 2
    s_and_b32 s68, s68, 7
    s_add_u32 m0, s43, 98304
    s_mul_i32 s68, s68, 128
    buffer_load_dwordx4 v8, s[4:7], s68 offen lds
    s_add_u32 m0, s43, 106496
    s_add_u32 s68, s68, 65536
    buffer_load_dwordx4 v8, s[4:7], s68 offen lds
    s_add_u32 s68, s39, 2
    s_and_b32 s68, s68, 7
    s_add_u32 m0, s43, 114688
    s_mul_i32 s68, s68, 196608
    buffer_load_dwordx4 v14, s[76:79], s68 offen lds
    s_add_u32 m0, s43, 122880
    s_add_u32 s68, s68, 98304
    buffer_load_dwordx4 v14, s[76:79], s68 offen lds
    s_add_u32 s68, s39, 3
    s_and_b32 s68, s68, 7
    s_add_u32 m0, s43, 131072
    s_mul_i32 s68, s68, 128
    s_waitcnt lgkmcnt(7)
    v_mfma_f32_32x32x16_bf16 v[96:111], v[128:131], v[32:35], 0
    buffer_load_dwordx4 v8, s[4:7], s68 offen lds
    ds_read_b128 v[136:139], v12
    ds_read_b64_tr_b16 v[48:49], v17 offset:24576
    ds_read_b64_tr_b16 v[50:51], v17 offset:25600
    s_waitcnt lgkmcnt(8)
    v_mfma_f32_32x32x16_bf16 v[112:127], v[128:131], v[36:39], 0
    ds_read_b64_tr_b16 v[52:53], v17 offset:24832
    ds_read_b64_tr_b16 v[54:55], v17 offset:25856
    ds_read_b128 v[140:143], v13
    s_add_u32 m0, s43, 139264
    s_add_u32 s68, s68, 65536
    s_waitcnt lgkmcnt(8)
    v_mfma_f32_32x32x16_bf16 v[96:111], v[132:135], v[40:43], v[96:111]
    buffer_load_dwordx4 v8, s[4:7], s68 offen lds
    ds_read_b64_tr_b16 v[56:57], v17 offset:28672
    ds_read_b64_tr_b16 v[58:59], v17 offset:29696
    ds_read_b64_tr_b16 v[60:61], v17 offset:28928
    s_waitcnt lgkmcnt(9)
    v_mfma_f32_32x32x16_bf16 v[112:127], v[132:135], v[44:47], v[112:127]
    ds_read_b64_tr_b16 v[62:63], v17 offset:29952
    s_waitcnt vmcnt(6)
    s_barrier
    v_add_u32 v10, 32768, v10
    v_add_u32 v11, 32768, v11
    v_add_u32 v12, 32768, v12
    v_add_u32 v13, 32768, v13
    v_add_u32 v17, 32768, v17
    s_add_u32 s68, s39, 3
    s_and_b32 s68, s68, 7
    s_add_u32 m0, s43, 147456
    s_mul_i32 s68, s68, 196608
    s_waitcnt lgkmcnt(7)
    v_mfma_f32_32x32x16_bf16 v[96:111], v[136:139], v[48:51], v[96:111]
    buffer_load_dwordx4 v14, s[76:79], s68 offen lds
    ds_read_b128 v[144:147], v10
    ds_read_b64_tr_b16 v[32:33], v17 offset:16384
    ds_read_b64_tr_b16 v[34:35], v17 offset:17408
    s_waitcnt lgkmcnt(8)
    v_mfma_f32_32x32x16_bf16 v[112:127], v[136:139], v[52:55], v[112:127]
    ds_read_b64_tr_b16 v[36:37], v17 offset:16640
    ds_read_b64_tr_b16 v[38:39], v17 offset:17664
    ds_read_b128 v[148:151], v11
    s_add_u32 m0, s43, 155648
    s_add_u32 s68, s68, 98304
    s_waitcnt lgkmcnt(8)
    v_mfma_f32_32x32x16_bf16 v[96:111], v[140:143], v[56:59], v[96:111]
    buffer_load_dwordx4 v14, s[76:79], s68 offen lds
    ds_read_b64_tr_b16 v[40:41], v17 offset:20480
    ds_read_b64_tr_b16 v[42:43], v17 offset:21504
    ds_read_b64_tr_b16 v[44:45], v17 offset:20736
    s_waitcnt lgkmcnt(9)
    v_mfma_f32_32x32x16_bf16 v[112:127], v[140:143], v[60:63], v[112:127]
    ds_read_b64_tr_b16 v[46:47], v17 offset:21760
    s_add_u32 s68, s39, 4
    s_and_b32 s68, s68, 7
    s_add_u32 m0, s43, 0
    s_mul_i32 s68, s68, 128
    s_waitcnt lgkmcnt(7)
    v_mfma_f32_32x32x16_bf16 v[96:111], v[144:147], v[32:35], v[96:111]
    buffer_load_dwordx4 v8, s[4:7], s68 offen lds
    ds_read_b128 v[152:155], v12
    ds_read_b64_tr_b16 v[48:49], v17 offset:24576
    ds_read_b64_tr_b16 v[50:51], v17 offset:25600
    s_waitcnt lgkmcnt(8)
    v_mfma_f32_32x32x16_bf16 v[112:127], v[144:147], v[36:39], v[112:127]
    ds_read_b64_tr_b16 v[52:53], v17 offset:24832
    ds_read_b64_tr_b16 v[54:55], v17 offset:25856
    ds_read_b128 v[156:159], v13
    s_add_u32 m0, s43, 8192
    s_add_u32 s68, s68, 65536
    s_waitcnt lgkmcnt(8)
    v_mfma_f32_32x32x16_bf16 v[96:111], v[148:151], v[40:43], v[96:111]
    buffer_load_dwordx4 v8, s[4:7], s68 offen lds
    ds_read_b64_tr_b16 v[56:57], v17 offset:28672
    ds_read_b64_tr_b16 v[58:59], v17 offset:29696
    ds_read_b64_tr_b16 v[60:61], v17 offset:28928
    s_waitcnt lgkmcnt(9)
    v_mfma_f32_32x32x16_bf16 v[112:127], v[148:151], v[44:47], v[112:127]
    ds_read_b64_tr_b16 v[62:63], v17 offset:29952
    s_waitcnt vmcnt(6)
    s_barrier
    v_mov_b32 v18, 0
    buffer_load_dwordx2 v[26:27], v18, s[32:35], 0 offen sc1
    v_add_u32 v10, 32768, v10
    v_add_u32 v11, 32768, v11
    v_add_u32 v12, 32768, v12
    v_add_u32 v13, 32768, v13
    v_add_u32 v17, 32768, v17
    s_add_u32 s68, s39, 4
    s_and_b32 s68, s68, 7
    s_add_u32 m0, s43, 16384
    s_mul_i32 s68, s68, 196608
    s_waitcnt lgkmcnt(7)
    v_mfma_f32_32x32x16_bf16 v[96:111], v[152:155], v[48:51], v[96:111]
    buffer_load_dwordx4 v14, s[76:79], s68 offen lds
    ds_read_b128 v[160:163], v10
    ds_read_b64_tr_b16 v[32:33], v17 offset:16384
    ds_read_b64_tr_b16 v[34:35], v17 offset:17408
    s_waitcnt lgkmcnt(8)
    v_mfma_f32_32x32x16_bf16 v[112:127], v[152:155], v[52:55], v[112:127]
    ds_read_b64_tr_b16 v[36:37], v17 offset:16640
    ds_read_b64_tr_b16 v[38:39], v17 offset:17664
    ds_read_b128 v[164:167], v11
    s_add_u32 m0, s43, 24576
    s_add_u32 s68, s68, 98304
    s_waitcnt lgkmcnt(8)
    v_mfma_f32_32x32x16_bf16 v[96:111], v[156:159], v[56:59], v[96:111]
    buffer_load_dwordx4 v14, s[76:79], s68 offen lds
    ds_read_b64_tr_b16 v[40:41], v17 offset:20480
    ds_read_b64_tr_b16 v[42:43], v17 offset:21504
    ds_read_b64_tr_b16 v[44:45], v17 offset:20736
    s_waitcnt lgkmcnt(9)
    v_mfma_f32_32x32x16_bf16 v[112:127], v[156:159], v[60:63], v[112:127]
    ds_read_b64_tr_b16 v[46:47], v17 offset:21760
    s_add_u32 s68, s39, 5
    s_and_b32 s68, s68, 7
    s_add_u32 m0, s43, 32768
    s_mul_i32 s68, s68, 128
    s_waitcnt lgkmcnt(7)
    v_mfma_f32_32x32x16_bf16 v[96:111], v[160:163], v[32:35], v[96:111]
    buffer_load_dwordx4 v8, s[4:7], s68 offen lds
    ds_read_b128 v[168:171], v12
    ds_read_b64_tr_b16 v[48:49], v17 offset:24576
    ds_read_b64_tr_b16 v[50:51], v17 offset:25600
    s_waitcnt lgkmcnt(8)
    v_mfma_f32_32x32x16_bf16 v[112:127], v[160:163], v[36:39], v[112:127]
    ds_read_b64_tr_b16 v[52:53], v17 offset:24832
    ds_read_b64_tr_b16 v[54:55], v17 offset:25856
    ds_read_b128 v[172:175], v13
    s_add_u32 m0, s43, 40960
    s_add_u32 s68, s68, 65536
    s_waitcnt lgkmcnt(8)
    v_mfma_f32_32x32x16_bf16 v[96:111], v[164:167], v[40:43], v[96:111]
    buffer_load_dwordx4 v8, s[4:7], s68 offen lds
    ds_read_b64_tr_b16 v[56:57], v17 offset:28672
    ds_read_b64_tr_b16 v[58:59], v17 offset:29696
    ds_read_b64_tr_b16 v[60:61], v17 offset:28928
    s_waitcnt lgkmcnt(9)
    v_mfma_f32_32x32x16_bf16 v[112:127], v[164:167], v[44:47], v[112:127]
    ds_read_b64_tr_b16 v[62:63], v17 offset:29952
    s_waitcnt vmcnt(7)
    s_barrier
    v_add_u32 v10, 32768, v10
    v_add_u32 v11, 32768, v11
    v_add_u32 v12, 32768, v12
    v_add_u32 v13, 32768, v13
    v_add_u32 v17, 32768, v17
    s_add_u32 s68, s39, 5
    s_and_b32 s68, s68, 7
    s_add_u32 m0, s43, 49152
    s_mul_i32 s68, s68, 196608
    s_waitcnt lgkmcnt(7)
    v_mfma_f32_32x32x16_bf16 v[96:111], v[168:171], v[48:51], v[96:111]
    buffer_load_dwordx4 v14, s[76:79], s68 offen lds
    ds_read_b128 v[176:179], v10
    ds_read_b64_tr_b16 v[32:33], v17 offset:16384
    ds_read_b64_tr_b16 v[34:35], v17 offset:17408
    s_waitcnt lgkmcnt(8)
    v_mfma_f32_32x32x16_bf16 v[112:127], v[168:171], v[52:55], v[112:127]
    ds_read_b64_tr_b16 v[36:37], v17 offset:16640
    ds_read_b64_tr_b16 v[38:39], v17 offset:17664
    ds_read_b128 v[180:183], v11
    s_add_u32 m0, s43, 57344
    s_add_u32 s68, s68, 98304
    s_waitcnt lgkmcnt(8)
    v_mfma_f32_32x32x16_bf16 v[96:111], v[172:175], v[56:59], v[96:111]
    buffer_load_dwordx4 v14, s[76:79], s68 offen lds
    ds_read_b64_tr_b16 v[40:41], v17 offset:20480
    ds_read_b64_tr_b16 v[42:43], v17 offset:21504
    ds_read_b64_tr_b16 v[44:45], v17 offset:20736
    s_waitcnt lgkmcnt(9)
    v_mfma_f32_32x32x16_bf16 v[112:127], v[172:175], v[60:63], v[112:127]
    ds_read_b64_tr_b16 v[46:47], v17 offset:21760
    s_add_u32 s68, s39, 6
    s_and_b32 s68, s68, 7
    s_add_u32 m0, s43, 65536
    s_mul_i32 s68, s68, 128
    s_waitcnt lgkmcnt(7)
    v_mfma_f32_32x32x16_bf16 v[96:111], v[176:179], v[32:35], v[96:111]
    buffer_load_dwordx4 v8, s[4:7], s68 offen lds
    ds_read_b128 v[184:187], v12
    ds_read_b64_tr_b16 v[48:49], v17 offset:24576
    ds_read_b64_tr_b16 v[50:51], v17 offset:25600
    s_waitcnt lgkmcnt(8)
    v_mfma_f32_32x32x16_bf16 v[112:127], v[176:179], v[36:39], v[112:127]
    ds_read_b64_tr_b16 v[52:53], v17 offset:24832
    ds_read_b64_tr_b16 v[54:55], v17 offset:25856
    ds_read_b128 v[188:191], v13
    s_add_u32 m0, s43, 73728
    s_add_u32 s68, s68, 65536
    s_waitcnt lgkmcnt(8)
    v_mfma_f32_32x32x16_bf16 v[96:111], v[180:183], v[40:43], v[96:111]
    buffer_load_dwordx4 v8, s[4:7], s68 offen lds
    ds_read_b64_tr_b16 v[56:57], v17 offset:28672
    ds_read_b64_tr_b16 v[58:59], v17 offset:29696
    ds_read_b64_tr_b16 v[60:61], v17 offset:28928
    s_waitcnt lgkmcnt(9)
    v_mfma_f32_32x32x16_bf16 v[112:127], v[180:183], v[44:47], v[112:127]
    ds_read_b64_tr_b16 v[62:63], v17 offset:29952
    s_waitcnt vmcnt(6)
    s_barrier
    v_add_u32 v10, 4294836224, v10
    v_add_u32 v11, 4294836224, v11
    v_add_u32 v12, 4294836224, v12
    v_add_u32 v13, 4294836224, v13
    v_add_u32 v17, 4294836224, v17
    s_add_u32 s68, s39, 6
    s_and_b32 s68, s68, 7
    s_add_u32 m0, s43, 81920
    s_mul_i32 s68, s68, 196608
    s_waitcnt lgkmcnt(7)
    v_mfma_f32_32x32x16_bf16 v[96:111], v[184:187], v[48:51], v[96:111]
    buffer_load_dwordx4 v14, s[76:79], s68 offen lds
    ds_read_b128 v[192:195], v10
    ds_read_b64_tr_b16 v[32:33], v17 offset:16384
    ds_read_b64_tr_b16 v[34:35], v17 offset:17408
    s_waitcnt lgkmcnt(8)
    v_mfma_f32_32x32x16_bf16 v[112:127], v[184:187], v[52:55], v[112:127]
    ds_read_b64_tr_b16 v[36:37], v17 offset:16640
    ds_read_b64_tr_b16 v[38:39], v17 offset:17664
    ds_read_b128 v[196:199], v11
    s_add_u32 m0, s43, 90112
    s_add_u32 s68, s68, 98304
    s_waitcnt lgkmcnt(8)
    v_mfma_f32_32x32x16_bf16 v[96:111], v[188:191], v[56:59], v[96:111]
    buffer_load_dwordx4 v14, s[76:79], s68 offen lds
    ds_read_b64_tr_b16 v[40:41], v17 offset:20480
    ds_read_b64_tr_b16 v[42:43], v17 offset:21504
    ds_read_b64_tr_b16 v[44:45], v17 offset:20736
    s_waitcnt lgkmcnt(9)
    v_mfma_f32_32x32x16_bf16 v[112:127], v[188:191], v[60:63], v[112:127]
    ds_read_b64_tr_b16 v[46:47], v17 offset:21760
    s_add_u32 s68, s39, 7
    s_and_b32 s68, s68, 7
    s_add_u32 m0, s43, 98304
    s_mul_i32 s68, s68, 128
    s_waitcnt lgkmcnt(7)
    v_mfma_f32_32x32x16_bf16 v[96:111], v[192:195], v[32:35], v[96:111]
    buffer_load_dwordx4 v8, s[4:7], s68 offen lds
    ds_read_b128 v[200:203], v12
    ds_read_b64_tr_b16 v[48:49], v17 offset:24576
    ds_read_b64_tr_b16 v[50:51], v17 offset:25600
    s_waitcnt lgkmcnt(8)
    v_mfma_f32_32x32x16_bf16 v[112:127], v[192:195], v[36:39], v[112:127]
    ds_read_b64_tr_b16 v[52:53], v17 offset:24832
    ds_read_b64_tr_b16 v[54:55], v17 offset:25856
    ds_read_b128 v[204:207], v13
    s_add_u32 m0, s43, 106496
    s_add_u32 s68, s68, 65536
    s_waitcnt lgkmcnt(8)
    v_mfma_f32_32x32x16_bf16 v[96:111], v[196:199], v[40:43], v[96:111]
    buffer_load_dwordx4 v8, s[4:7], s68 offen lds
    ds_read_b64_tr_b16 v[56:57], v17 offset:28672
    ds_read_b64_tr_b16 v[58:59], v17 offset:29696
    ds_read_b64_tr_b16 v[60:61], v17 offset:28928
    s_waitcnt lgkmcnt(9)
    v_mfma_f32_32x32x16_bf16 v[112:127], v[196:199], v[44:47], v[112:127]
    ds_read_b64_tr_b16 v[62:63], v17 offset:29952
    s_waitcnt vmcnt(6)
    s_barrier
    v_add_u32 v10, 32768, v10
    v_add_u32 v11, 32768, v11
    v_add_u32 v12, 32768, v12
    v_add_u32 v13, 32768, v13
    v_add_u32 v17, 32768, v17
    s_add_u32 s68, s39, 7
    s_and_b32 s68, s68, 7
    s_add_u32 m0, s43, 114688
    s_mul_i32 s68, s68, 196608
    s_waitcnt lgkmcnt(7)
    v_mfma_f32_32x32x16_bf16 v[96:111], v[200:203], v[48:51], v[96:111]
    buffer_load_dwordx4 v14, s[76:79], s68 offen lds
    ds_read_b128 v[208:211], v10
    ds_read_b64_tr_b16 v[32:33], v17 offset:16384
    ds_read_b64_tr_b16 v[34:35], v17 offset:17408
    s_waitcnt lgkmcnt(8)
    v_mfma_f32_32x32x16_bf16 v[112:127], v[200:203], v[52:55], v[112:127]
    ds_read_b64_tr_b16 v[36:37], v17 offset:16640
    ds_read_b64_tr_b16 v[38:39], v17 offset:17664
    ds_read_b128 v[212:215], v11
    s_add_u32 m0, s43, 122880
    s_add_u32 s68, s68, 98304
    s_waitcnt lgkmcnt(8)
    v_mfma_f32_32x32x16_bf16 v[96:111], v[204:207], v[56:59], v[96:111]
    buffer_load_dwordx4 v14, s[76:79], s68 offen lds
    ds_read_b64_tr_b16 v[40:41], v17 offset:20480
    ds_read_b64_tr_b16 v[42:43], v17 offset:21504
    ds_read_b64_tr_b16 v[44:45], v17 offset:20736
    s_waitcnt lgkmcnt(9)
    v_mfma_f32_32x32x16_bf16 v[112:127], v[204:207], v[60:63], v[112:127]
    ds_read_b64_tr_b16 v[46:47], v17 offset:21760
    s_add_u32 s68, s39, 0
    s_and_b32 s68, s68, 7
    s_add_u32 m0, s43, 131072
    s_mul_i32 s68, s68, 196608
    s_waitcnt lgkmcnt(7)
    v_mfma_f32_32x32x16_bf16 v[96:111], v[208:211], v[32:35], v[96:111]
    buffer_load_dwordx4 v9, s[76:79], s68 offen lds
    ds_read_b128 v[216:219], v12
    ds_read_b64_tr_b16 v[48:49], v17 offset:24576
    ds_read_b64_tr_b16 v[50:51], v17 offset:25600
    s_waitcnt lgkmcnt(8)
    v_mfma_f32_32x32x16_bf16 v[112:127], v[208:211], v[36:39], v[112:127]
    ds_read_b64_tr_b16 v[52:53], v17 offset:24832
    ds_read_b64_tr_b16 v[54:55], v17 offset:25856
    ds_read_b128 v[220:223], v13
    s_add_u32 s68, s39, 1
    s_and_b32 s68, s68, 7
    s_add_u32 m0, s43, 139264
    s_mul_i32 s68, s68, 196608
    s_waitcnt lgkmcnt(8)
    v_mfma_f32_32x32x16_bf16 v[96:111], v[212:215], v[40:43], v[96:111]
    buffer_load_dwordx4 v9, s[76:79], s68 offen lds
    ds_read_b64_tr_b16 v[56:57], v17 offset:28672
    ds_read_b64_tr_b16 v[58:59], v17 offset:29696
    ds_read_b64_tr_b16 v[60:61], v17 offset:28928
    s_waitcnt lgkmcnt(9)
    v_mfma_f32_32x32x16_bf16 v[112:127], v[212:215], v[44:47], v[112:127]
    ds_read_b64_tr_b16 v[62:63], v17 offset:29952
    s_waitcnt vmcnt(6)
    s_barrier
    v_add_u32 v10, 32768, v10
    v_add_u32 v11, 32768, v11
    v_add_u32 v12, 32768, v12
    v_add_u32 v13, 32768, v13
    v_add_u32 v17, 32768, v17
    s_add_u32 s68, s39, 2
    s_and_b32 s68, s68, 7
    s_add_u32 m0, s43, 147456
    s_mul_i32 s68, s68, 196608
    s_waitcnt lgkmcnt(7)
    v_mfma_f32_32x32x16_bf16 v[96:111], v[216:219], v[48:51], v[96:111]
    buffer_load_dwordx4 v9, s[76:79], s68 offen lds
    ds_read_b128 v[224:227], v10
    ds_read_b64_tr_b16 v[32:33], v17 offset:16384
    ds_read_b64_tr_b16 v[34:35], v17 offset:17408
    s_waitcnt lgkmcnt(8)
    v_mfma_f32_32x32x16_bf16 v[112:127], v[216:219], v[52:55], v[112:127]
    ds_read_b64_tr_b16 v[36:37], v17 offset:16640
    ds_read_b64_tr_b16 v[38:39], v17 offset:17664
    ds_read_b128 v[228:231], v11
    s_add_u32 s68, s39, 3
    s_and_b32 s68, s68, 7
    s_add_u32 m0, s43, 155648
    s_mul_i32 s68, s68, 196608
    s_waitcnt lgkmcnt(8)
    v_mfma_f32_32x32x16_bf16 v[96:111], v[220:223], v[56:59], v[96:111]
    buffer_load_dwordx4 v9, s[76:79], s68 offen lds
    ds_read_b64_tr_b16 v[40:41], v17 offset:20480
    ds_read_b64_tr_b16 v[42:43], v17 offset:21504
    ds_read_b64_tr_b16 v[44:45], v17 offset:20736
    s_waitcnt lgkmcnt(9)
    v_mfma_f32_32x32x16_bf16 v[112:127], v[220:223], v[60:63], v[112:127]
    ds_read_b64_tr_b16 v[46:47], v17 offset:21760
    s_add_u32 s68, s39, 4
    s_and_b32 s68, s68, 7
    s_add_u32 m0, s43, 0
    s_mul_i32 s68, s68, 196608
    s_waitcnt lgkmcnt(7)
    v_mfma_f32_32x32x16_bf16 v[96:111], v[224:227], v[32:35], v[96:111]
    buffer_load_dwordx4 v9, s[76:79], s68 offen lds
    ds_read_b128 v[232:235], v12
    ds_read_b64_tr_b16 v[48:49], v17 offset:24576
    ds_read_b64_tr_b16 v[50:51], v17 offset:25600
    s_waitcnt lgkmcnt(8)
    v_mfma_f32_32x32x16_bf16 v[112:127], v[224:227], v[36:39], v[112:127]
    ds_read_b64_tr_b16 v[52:53], v17 offset:24832
    ds_read_b64_tr_b16 v[54:55], v17 offset:25856
    ds_read_b128 v[236:239], v13
    s_add_u32 s68, s39, 5
    s_and_b32 s68, s68, 7
    s_add_u32 m0, s43, 8192
    s_mul_i32 s68, s68, 196608
    s_waitcnt lgkmcnt(8)
    v_mfma_f32_32x32x16_bf16 v[96:111], v[228:231], v[40:43], v[96:111]
    buffer_load_dwordx4 v9, s[76:79], s68 offen lds
    ds_read_b64_tr_b16 v[56:57], v17 offset:28672
    ds_read_b64_tr_b16 v[58:59], v17 offset:29696
    ds_read_b64_tr_b16 v[60:61], v17 offset:28928
    s_waitcnt lgkmcnt(9)
    v_mfma_f32_32x32x16_bf16 v[112:127], v[228:231], v[44:47], v[112:127]
    ds_read_b64_tr_b16 v[62:63], v17 offset:29952
    s_waitcnt vmcnt(6)
    s_barrier
    s_mov_b32 s58, 0x40000
Lchk_10:
    v_readfirstlane_b32 s54, v26
    v_readfirstlane_b32 s55, v27
    s_cmp_lg_u32 s55, 0
    s_cbranch_scc0 Lrt_11
Lok_12:
    v_add_u32 v10, 32768, v10
    v_add_u32 v11, 32768, v11
    v_add_u32 v12, 32768, v12
    v_add_u32 v13, 32768, v13
    v_add_u32 v17, 32768, v17
    s_add_u32 s68, s39, 6
    s_and_b32 s68, s68, 7
    s_add_u32 m0, s43, 16384
    s_mul_i32 s68, s68, 196608
    s_waitcnt lgkmcnt(7)
    v_mfma_f32_32x32x16_bf16 v[96:111], v[232:235], v[48:51], v[96:111]
    buffer_load_dwordx4 v9, s[76:79], s68 offen lds
    ds_read_b128 v[240:243], v10
    ds_read_b64_tr_b16 v[32:33], v17 offset:16384
    ds_read_b64_tr_b16 v[34:35], v17 offset:17408
    s_waitcnt lgkmcnt(8)
    v_mfma_f32_32x32x16_bf16 v[112:127], v[232:235], v[52:55], v[112:127]
    ds_read_b64_tr_b16 v[36:37], v17 offset:16640
    ds_read_b64_tr_b16 v[38:39], v17 offset:17664
    ds_read_b128 v[244:247], v11
    s_add_u32 s68, s39, 7
    s_and_b32 s68, s68, 7
    s_add_u32 m0, s43, 24576
    s_mul_i32 s68, s68, 196608
    s_waitcnt lgkmcnt(8)
    v_mfma_f32_32x32x16_bf16 v[96:111], v[236:239], v[56:59], v[96:111]
    buffer_load_dwordx4 v9, s[76:79], s68 offen lds
    ds_read_b64_tr_b16 v[40:41], v17 offset:20480
    ds_read_b64_tr_b16 v[42:43], v17 offset:21504
    ds_read_b64_tr_b16 v[44:45], v17 offset:20736
    s_waitcnt lgkmcnt(9)
    v_mfma_f32_32x32x16_bf16 v[112:127], v[236:239], v[60:63], v[112:127]
    ds_read_b64_tr_b16 v[46:47], v17 offset:21760
    s_add_u32 s68, s39, 0
    s_and_b32 s68, s68, 7
    s_add_u32 m0, s43, 32768
    s_mul_i32 s68, s68, 229376
    s_waitcnt lgkmcnt(7)
    v_mfma_f32_32x32x16_bf16 v[96:111], v[240:243], v[32:35], v[96:111]
    buffer_load_dwordx4 v15, s[8:11], s68 offen lds
    ds_read_b128 v[248:251], v12
    ds_read_b64_tr_b16 v[48:49], v17 offset:24576
    ds_read_b64_tr_b16 v[50:51], v17 offset:25600
    s_waitcnt lgkmcnt(8)
    v_mfma_f32_32x32x16_bf16 v[112:127], v[240:243], v[36:39], v[112:127]
    ds_read_b64_tr_b16 v[52:53], v17 offset:24832
    ds_read_b64_tr_b16 v[54:55], v17 offset:25856
    ds_read_b128 v[252:255], v13
    s_add_u32 m0, s43, 40960
    s_waitcnt lgkmcnt(8)
    v_mfma_f32_32x32x16_bf16 v[96:111], v[244:247], v[40:43], v[96:111]
    buffer_load_dwordx4 v15, s[12:15], s68 offen lds
    ds_read_b64_tr_b16 v[56:57], v17 offset:28672
    ds_read_b64_tr_b16 v[58:59], v17 offset:29696
    ds_read_b64_tr_b16 v[60:61], v17 offset:28928
    s_waitcnt lgkmcnt(9)
    v_mfma_f32_32x32x16_bf16 v[112:127], v[244:247], v[44:47], v[112:127]
    ds_read_b64_tr_b16 v[62:63], v17 offset:29952
    s_waitcnt vmcnt(6)
    s_barrier
    s_lshl_b32 s44, s40, 3
    s_and_b32 s45, s38, 1
    s_lshl_b32 s45, s45, 2
    s_add_u32 s44, s44, s45
    s_lshr_b32 s45, s36, 2
    s_lshl_b32 s45, s45, 1
    s_add_u32 s44, s44, s45
    s_lshl_b32 s44, s44, 6
    s_add_u32 s44, s44, s41
    s_lshl_b32 s44, s44, 10
    s_lshr_b32 s56, s38, 1
    s_lshl_b32 s70, s44, s56
    s_mul_i32 s57, s56, 2097152
    s_add_u32 s70, s70, s57
    s_lshl_b32 s57, 65536, s56
    s_add_u32 s71, s70, s57
    s_lshl_b32 s72, s40, 20
    s_lshl_b32 s45, s45, 18
    s_add_u32 s72, s72, s45
    s_lshl_b32 s45, s41, 11
    s_add_u32 s72, s72, s45
    s_add_u32 s72, s72, 2097152
    s_add_u32 s74, s72, 262144
    v_bfe_u32 v4, v2, 4, 1
    v_lshlrev_b32 v5, 17, v4
    v_lshrrev_b32 v4, 5, v2
    v_lshl_add_u32 v5, v4, 8, v5
    v_and_b32_e64 v4, 15, v2
    v_lshl_add_u32 v5, v4, 4, v5
    v_add_u32 v16, 98304, v16
    s_add_u32 s68, s39, 1
    s_and_b32 s68, s68, 7
    s_add_u32 m0, s43, 49152
    s_mul_i32 s68, s68, 229376
    s_waitcnt lgkmcnt(7)
    v_mfma_f32_32x32x16_bf16 v[96:111], v[248:251], v[48:51], v[96:111]
    buffer_load_dwordx4 v15, s[8:11], s68 offen lds
    ds_read_b64_tr_b16 v[32:33], v16 offset:0
    ds_read_b64_tr_b16 v[34:35], v16 offset:512
    s_waitcnt lgkmcnt(7)
    v_mfma_f32_32x32x16_bf16 v[112:127], v[248:251], v[52:55], v[112:127]
    ds_read_b64_tr_b16 v[36:37], v16 offset:2048
    ds_read_b64_tr_b16 v[38:39], v16 offset:2560
    s_add_u32 m0, s43, 57344
    s_waitcnt lgkmcnt(6)
    v_mfma_f32_32x32x16_bf16 v[96:111], v[252:255], v[56:59], v[96:111]
    buffer_load_dwordx4 v15, s[12:15], s68 offen lds
    ds_read_b64_tr_b16 v[40:41], v16 offset:4096
    ds_read_b64_tr_b16 v[42:43], v16 offset:4608
    s_waitcnt lgkmcnt(6)
    v_mfma_f32_32x32x16_bf16 v[112:127], v[252:255], v[60:63], v[112:127]
    ds_read_b64_tr_b16 v[44:45], v16 offset:6144
    ds_read_b64_tr_b16 v[46:47], v16 offset:6656
    s_add_u32 s68, s39, 2
    s_and_b32 s68, s68, 7
    s_add_u32 m0, s43, 65536
    s_mul_i32 s68, s68, 229376
    s_waitcnt lgkmcnt(6)
    v_mfma_f32_32x32x16_bf16 v[80:95], v[32:35], v[128:131], 0
    buffer_load_dwordx4 v15, s[8:11], s68 offen lds
    ds_read_b64_tr_b16 v[48:49], v16 offset:8192
    ds_read_b64_tr_b16 v[50:51], v16 offset:8704
    s_add_u32 m0, s43, 73728
    s_waitcnt lgkmcnt(6)
    v_mfma_f32_32x32x16_bf16 v[80:95], v[36:39], v[132:135], v[80:95]
    buffer_load_dwordx4 v15, s[12:15], s68 offen lds
    ds_read_b64_tr_b16 v[52:53], v16 offset:10240
    ds_read_b64_tr_b16 v[54:55], v16 offset:10752
    s_add_u32 s68, s39, 3
    s_and_b32 s68, s68, 7
    s_add_u32 m0, s43, 81920
    s_mul_i32 s68, s68, 229376
    s_waitcnt lgkmcnt(6)
    v_mfma_f32_32x32x16_bf16 v[80:95], v[40:43], v[136:139], v[80:95]
    buffer_load_dwordx4 v15, s[8:11], s68 offen lds
    ds_read_b64_tr_b16 v[56:57], v16 offset:12288
    ds_read_b64_tr_b16 v[58:59], v16 offset:12800
    s_add_u32 m0, s43, 90112
    s_waitcnt lgkmcnt(6)
    v_mfma_f32_32x32x16_bf16 v[80:95], v[44:47], v[140:143], v[80:95]
    buffer_load_dwordx4 v15, s[12:15], s68 offen lds
    ds_read_b64_tr_b16 v[60:61], v16 offset:14336
    ds_read_b64_tr_b16 v[62:63], v16 offset:14848
    s_waitcnt lgkmcnt(6)
    v_mfma_f32_32x32x16_bf16 v[80:95], v[48:51], v[144:147], v[80:95]
    ds_read_b64_tr_b16 v[32:33], v16 offset:16384
    ds_read_b64_tr_b16 v[34:35], v16 offset:16896
    s_waitcnt lgkmcnt(6)
    v_mfma_f32_32x32x16_bf16 v[80:95], v[52:55], v[148:151], v[80:95]
    ds_read_b64_tr_b16 v[36:37], v16 offset:18432
    ds_read_b64_tr_b16 v[38:39], v16 offset:18944
    s_waitcnt lgkmcnt(6)
    v_mfma_f32_32x32x16_bf16 v[80:95], v[56:59], v[152:155], v[80:95]
    ds_read_b64_tr_b16 v[40:41], v16 offset:20480
    ds_read_b64_tr_b16 v[42:43], v16 offset:20992
    s_waitcnt lgkmcnt(6)
    v_mfma_f32_32x32x16_bf16 v[80:95], v[60:63], v[156:159], v[80:95]
    ds_read_b64_tr_b16 v[44:45], v16 offset:22528
    ds_read_b64_tr_b16 v[46:47], v16 offset:23040
    s_waitcnt vmcnt(8)
    s_barrier
    s_add_u32 s68, s39, 4
    s_and_b32 s68, s68, 7
    s_add_u32 m0, s43, 98304
    s_mul_i32 s68, s68, 229376
    s_waitcnt lgkmcnt(6)
    v_mfma_f32_32x32x16_bf16 v[80:95], v[32:35], v[160:163], v[80:95]
    buffer_load_dwordx4 v15, s[8:11], s68 offen lds
    ds_read_b64_tr_b16 v[48:49], v16 offset:24576
    ds_read_b64_tr_b16 v[50:51], v16 offset:25088
    s_add_u32 m0, s43, 106496
    s_waitcnt lgkmcnt(6)
    v_mfma_f32_32x32x16_bf16 v[80:95], v[36:39], v[164:167], v[80:95]
    buffer_load_dwordx4 v15, s[12:15], s68 offen lds
    ds_read_b64_tr_b16 v[52:53], v16 offset:26624
    ds_read_b64_tr_b16 v[54:55], v16 offset:27136
    s_add_u32 s68, s39, 5
    s_and_b32 s68, s68, 7
    s_add_u32 m0, s43, 114688
    s_mul_i32 s68, s68, 229376
    s_waitcnt lgkmcnt(6)
    v_mfma_f32_32x32x16_bf16 v[80:95], v[40:43], v[168:171], v[80:95]
    buffer_load_dwordx4 v15, s[8:11], s68 offen lds
    ds_read_b64_tr_b16 v[56:57], v16 offset:28672
    ds_read_b64_tr_b16 v[58:59], v16 offset:29184
    s_add_u32 m0, s43, 122880
    s_waitcnt lgkmcnt(6)
    v_mfma_f32_32x32x16_bf16 v[80:95], v[44:47], v[172:175], v[80:95]
    buffer_load_dwordx4 v15, s[12:15], s68 offen lds
    ds_read_b64_tr_b16 v[60:61], v16 offset:30720
    ds_read_b64_tr_b16 v[62:63], v16 offset:31232
    v_add_u32 v16, 4294836224, v16
    s_waitcnt lgkmcnt(6)
    v_mfma_f32_32x32x16_bf16 v[80:95], v[48:51], v[176:179], v[80:95]
    ds_read_b64_tr_b16 v[32:33], v16 offset:0
    ds_read_b64_tr_b16 v[34:35], v16 offset:512
    s_waitcnt lgkmcnt(6)
    v_mfma_f32_32x32x16_bf16 v[80:95], v[52:55], v[180:183], v[80:95]
    ds_read_b64_tr_b16 v[36:37], v16 offset:2048
    ds_read_b64_tr_b16 v[38:39], v16 offset:2560
    v_cvt_pk_bf16_f32 v96, v96, v97
    v_cvt_pk_bf16_f32 v97, v98, v99
    v_cvt_pk_bf16_f32 v98, v100, v101
    v_cvt_pk_bf16_f32 v99, v102, v103
    buffer_store_dwordx4 v[96:99], v5, s[16:19], s72 offen offset:1024 sc1
    s_waitcnt lgkmcnt(6)
    v_mfma_f32_32x32x16_bf16 v[80:95], v[56:59], v[184:187], v[80:95]
    ds_read_b64_tr_b16 v[40:41], v16 offset:4096
    ds_read_b64_tr_b16 v[42:43], v16 offset:4608
    s_waitcnt lgkmcnt(6)
    v_mfma_f32_32x32x16_bf16 v[80:95], v[60:63], v[188:191], v[80:95]
    ds_read_b64_tr_b16 v[44:45], v16 offset:6144
    ds_read_b64_tr_b16 v[46:47], v16 offset:6656
    s_waitcnt lgkmcnt(6)
    v_mfma_f32_32x32x16_bf16 v[80:95], v[32:35], v[192:195], v[80:95]
    ds_read_b64_tr_b16 v[48:49], v16 offset:8192
    ds_read_b64_tr_b16 v[50:51], v16 offset:8704
    s_waitcnt lgkmcnt(6)
    v_mfma_f32_32x32x16_bf16 v[80:95], v[36:39], v[196:199], v[80:95]
    ds_read_b64_tr_b16 v[52:53], v16 offset:10240
    ds_read_b64_tr_b16 v[54:55], v16 offset:10752
    s_waitcnt lgkmcnt(6)
    v_mfma_f32_32x32x16_bf16 v[80:95], v[40:43], v[200:203], v[80:95]
    ds_read_b64_tr_b16 v[56:57], v16 offset:12288
    ds_read_b64_tr_b16 v[58:59], v16 offset:12800
    v_cvt_pk_bf16_f32 v100, v104, v105
    v_cvt_pk_bf16_f32 v101, v106, v107
    v_cvt_pk_bf16_f32 v102, v108, v109
    v_cvt_pk_bf16_f32 v103, v110, v111
    buffer_store_dwordx4 v[100:103], v5, s[16:19], s72 offen offset:1536 sc1
    s_waitcnt lgkmcnt(6)
    v_mfma_f32_32x32x16_bf16 v[80:95], v[44:47], v[204:207], v[80:95]
    ds_read_b64_tr_b16 v[60:61], v16 offset:14336
    ds_read_b64_tr_b16 v[62:63], v16 offset:14848
    s_waitcnt lgkmcnt(6)
    v_mfma_f32_32x32x16_bf16 v[80:95], v[48:51], v[208:211], v[80:95]
    ds_read_b64_tr_b16 v[32:33], v16 offset:16384
    ds_read_b64_tr_b16 v[34:35], v16 offset:16896
    s_waitcnt lgkmcnt(6)
    v_mfma_f32_32x32x16_bf16 v[80:95], v[52:55], v[212:215], v[80:95]
    ds_read_b64_tr_b16 v[36:37], v16 offset:18432
    ds_read_b64_tr_b16 v[38:39], v16 offset:18944
    s_waitcnt lgkmcnt(6)
    v_mfma_f32_32x32x16_bf16 v[80:95], v[56:59], v[216:219], v[80:95]
    ds_read_b64_tr_b16 v[40:41], v16 offset:20480
    ds_read_b64_tr_b16 v[42:43], v16 offset:20992
    s_waitcnt lgkmcnt(6)
    v_mfma_f32_32x32x16_bf16 v[80:95], v[60:63], v[220:223], v[80:95]
    ds_read_b64_tr_b16 v[44:45], v16 offset:22528
    ds_read_b64_tr_b16 v[46:47], v16 offset:23040
    v_cvt_pk_bf16_f32 v112, v112, v113
    v_cvt_pk_bf16_f32 v113, v114, v115
    v_cvt_pk_bf16_f32 v114, v116, v117
    v_cvt_pk_bf16_f32 v115, v118, v119
    buffer_store_dwordx4 v[112:115], v5, s[16:19], s74 offen offset:1024 sc1
    s_waitcnt lgkmcnt(6)
    v_mfma_f32_32x32x16_bf16 v[80:95], v[32:35], v[224:227], v[80:95]
    ds_read_b64_tr_b16 v[48:49], v16 offset:24576
    ds_read_b64_tr_b16 v[50:51], v16 offset:25088
    s_waitcnt lgkmcnt(6)
    v_mfma_f32_32x32x16_bf16 v[80:95], v[36:39], v[228:231], v[80:95]
    ds_read_b64_tr_b16 v[52:53], v16 offset:26624
    ds_read_b64_tr_b16 v[54:55], v16 offset:27136
    s_waitcnt lgkmcnt(6)
    v_mfma_f32_32x32x16_bf16 v[80:95], v[40:43], v[232:235], v[80:95]
    ds_read_b64_tr_b16 v[56:57], v16 offset:28672
    ds_read_b64_tr_b16 v[58:59], v16 offset:29184
    s_waitcnt lgkmcnt(6)
    v_mfma_f32_32x32x16_bf16 v[80:95], v[44:47], v[236:239], v[80:95]
    ds_read_b64_tr_b16 v[60:61], v16 offset:30720
    ds_read_b64_tr_b16 v[62:63], v16 offset:31232
    s_waitcnt vmcnt(11)
    s_barrier
    v_add_u32 v16, 32768, v16
    v_bfe_u32 v17, v2, 4, 1
    v_lshl_add_u32 v16, v17, 11, v16
    v_xor_b32 v17, 32, v16
    s_waitcnt lgkmcnt(6)
    v_mfma_f32_32x32x16_bf16 v[80:95], v[48:51], v[240:243], v[80:95]
    ds_read_b64_tr_b16 v[32:33], v16 offset:0
    ds_read_b64_tr_b16 v[34:35], v16 offset:512
    v_cvt_pk_bf16_f32 v116, v120, v121
    v_cvt_pk_bf16_f32 v117, v122, v123
    v_cvt_pk_bf16_f32 v118, v124, v125
    v_cvt_pk_bf16_f32 v119, v126, v127
    buffer_store_dwordx4 v[116:119], v5, s[16:19], s74 offen offset:1536 sc1
    s_add_u32 s68, s39, 6
    s_and_b32 s68, s68, 7
    s_add_u32 m0, s43, 131072
    s_mul_i32 s68, s68, 229376
    s_waitcnt lgkmcnt(6)
    v_mfma_f32_32x32x16_bf16 v[80:95], v[52:55], v[244:247], v[80:95]
    buffer_load_dwordx4 v15, s[8:11], s68 offen lds
    ds_read_b64_tr_b16 v[36:37], v16 offset:8192
    ds_read_b64_tr_b16 v[38:39], v16 offset:8704
    v_permlane16_swap_b32 v128, v132
    v_permlane16_swap_b32 v129, v133
    v_permlane16_swap_b32 v130, v134
    v_permlane16_swap_b32 v131, v135
    s_add_u32 m0, s43, 139264
    s_waitcnt lgkmcnt(6)
    v_mfma_f32_32x32x16_bf16 v[80:95], v[56:59], v[248:251], v[80:95]
    buffer_load_dwordx4 v15, s[12:15], s68 offen lds
    ds_read_b64_tr_b16 v[40:41], v17 offset:0
    ds_read_b64_tr_b16 v[42:43], v17 offset:512
    s_add_u32 s68, s39, 7
    s_and_b32 s68, s68, 7
    s_add_u32 m0, s43, 147456
    s_mul_i32 s68, s68, 229376
    s_waitcnt lgkmcnt(6)
    v_mfma_f32_32x32x16_bf16 v[80:95], v[60:63], v[252:255], v[80:95]
    buffer_load_dwordx4 v15, s[8:11], s68 offen lds
    ds_read_b64_tr_b16 v[44:45], v17 offset:8192
    ds_read_b64_tr_b16 v[46:47], v17 offset:8704
    s_waitcnt lgkmcnt(6)
    v_mfma_f32_16x16x32_bf16 v[64:67], v[32:35], v[128:131], 0
    ds_read_b64_tr_b16 v[48:49], v16 offset:4096
    ds_read_b64_tr_b16 v[50:51], v16 offset:4608
    v_mfma_f32_16x16x32_bf16 v[68:71], v[32:35], v[132:135], 0
    s_nop 7
    v_cvt_pk_bf16_f32 v18, v80, v81
    v_cvt_pk_bf16_f32 v19, v82, v83
    v_cvt_pk_bf16_f32 v20, v84, v85
    v_cvt_pk_bf16_f32 v21, v86, v87
    buffer_store_dwordx4 v[18:21], v3, s[16:19], s70 offen sc1
    v_cvt_pk_bf16_f32 v22, v88, v89
    v_cvt_pk_bf16_f32 v23, v90, v91
    v_cvt_pk_bf16_f32 v24, v92, v93
    v_cvt_pk_bf16_f32 v25, v94, v95
    s_add_u32 m0, s43, 155648
    s_waitcnt lgkmcnt(6)
    v_mfma_f32_16x16x32_bf16 v[80:83], v[36:39], v[128:131], 0
    ds_read_b64_tr_b16 v[52:53], v16 offset:12288
    ds_read_b64_tr_b16 v[54:55], v16 offset:12800
    v_mfma_f32_16x16x32_bf16 v[84:87], v[36:39], v[132:135], 0
    buffer_load_dwordx4 v15, s[12:15], s68 offen lds
    v_permlane16_swap_b32 v136, v140
    v_permlane16_swap_b32 v137, v141
    v_permlane16_swap_b32 v138, v142
    v_permlane16_swap_b32 v139, v143
    s_waitcnt lgkmcnt(6)
    v_mfma_f32_16x16x32_bf16 v[72:75], v[40:43], v[128:131], 0
    ds_read_b64_tr_b16 v[56:57], v17 offset:4096
    ds_read_b64_tr_b16 v[58:59], v17 offset:4608
    v_mfma_f32_16x16x32_bf16 v[76:79], v[40:43], v[132:135], 0
    s_waitcnt lgkmcnt(6)
    v_mfma_f32_16x16x32_bf16 v[88:91], v[44:47], v[128:131], 0
    ds_read_b64_tr_b16 v[60:61], v17 offset:12288
    ds_read_b64_tr_b16 v[62:63], v17 offset:12800
    v_mfma_f32_16x16x32_bf16 v[92:95], v[44:47], v[132:135], 0
    s_waitcnt lgkmcnt(6)
    v_mfma_f32_16x16x32_bf16 v[64:67], v[48:51], v[136:139], v[64:67]
    ds_read_b64_tr_b16 v[32:33], v16 offset:16384
    ds_read_b64_tr_b16 v[34:35], v16 offset:16896
    v_mfma_f32_16x16x32_bf16 v[68:71], v[48:51], v[140:143], v[68:71]
    buffer_store_dwordx4 v[22:25], v3, s[16:19], s71 offen sc1
    s_waitcnt lgkmcnt(6)
    v_mfma_f32_16x16x32_bf16 v[80:83], v[52:55], v[136:139], v[80:83]
    ds_read_b64_tr_b16 v[36:37], v16 offset:24576
    ds_read_b64_tr_b16 v[38:39], v16 offset:25088
    v_mfma_f32_16x16x32_bf16 v[84:87], v[52:55], v[140:143], v[84:87]
    v_permlane16_swap_b32 v144, v148
    v_permlane16_swap_b32 v145, v149
    v_permlane16_swap_b32 v146, v150
    v_permlane16_swap_b32 v147, v151
    s_waitcnt lgkmcnt(6)
    v_mfma_f32_16x16x32_bf16 v[72:75], v[56:59], v[136:139], v[72:75]
    ds_read_b64_tr_b16 v[40:41], v17 offset:16384
    ds_read_b64_tr_b16 v[42:43], v17 offset:16896
    v_mfma_f32_16x16x32_bf16 v[76:79], v[56:59], v[140:143], v[76:79]
    s_waitcnt lgkmcnt(6)
    v_mfma_f32_16x16x32_bf16 v[88:91], v[60:63], v[136:139], v[88:91]
    ds_read_b64_tr_b16 v[44:45], v17 offset:24576
    ds_read_b64_tr_b16 v[46:47], v17 offset:25088
    v_mfma_f32_16x16x32_bf16 v[92:95], v[60:63], v[140:143], v[92:95]
    s_waitcnt lgkmcnt(6)
    v_mfma_f32_16x16x32_bf16 v[64:67], v[32:35], v[144:147], v[64:67]
    ds_read_b64_tr_b16 v[48:49], v16 offset:20480
    ds_read_b64_tr_b16 v[50:51], v16 offset:20992
    v_mfma_f32_16x16x32_bf16 v[68:71], v[32:35], v[148:151], v[68:71]
    s_waitcnt lgkmcnt(6)
    v_mfma_f32_16x16x32_bf16 v[80:83], v[36:39], v[144:147], v[80:83]
    ds_read_b64_tr_b16 v[52:53], v16 offset:28672
    ds_read_b64_tr_b16 v[54:55], v16 offset:29184
    v_mfma_f32_16x16x32_bf16 v[84:87], v[36:39], v[148:151], v[84:87]
    v_permlane16_swap_b32 v152, v156
    v_permlane16_swap_b32 v153, v157
    v_permlane16_swap_b32 v154, v158
    v_permlane16_swap_b32 v155, v159
    s_waitcnt lgkmcnt(6)
    v_mfma_f32_16x16x32_bf16 v[72:75], v[40:43], v[144:147], v[72:75]
    ds_read_b64_tr_b16 v[56:57], v17 offset:20480
    ds_read_b64_tr_b16 v[58:59], v17 offset:20992
    v_mfma_f32_16x16x32_bf16 v[76:79], v[40:43], v[148:151], v[76:79]
    s_waitcnt lgkmcnt(6)
    v_mfma_f32_16x16x32_bf16 v[88:91], v[44:47], v[144:147], v[88:91]
    ds_read_b64_tr_b16 v[60:61], v17 offset:28672
    ds_read_b64_tr_b16 v[62:63], v17 offset:29184
    v_mfma_f32_16x16x32_bf16 v[92:95], v[44:47], v[148:151], v[92:95]
    s_waitcnt vmcnt(14)
    s_barrier
    s_mul_i32 s72, s41, 114688
    s_mul_i32 s45, s40, 28672
    s_add_u32 s72, s72, s45
    s_lshl_b32 s45, s38, 13
    s_add_u32 s72, s72, s45
    s_and_b32 s56, s36, 4
    s_lshl_b32 s45, s56, 9
    s_add_u32 s72, s72, s45
    s_add_u32 s72, s72, 8388608
    s_lshl_b32 s70, s41, 12
    s_lshl_b32 s45, s40, 10
    s_add_u32 s70, s70, s45
    s_lshl_b32 s45, s38, 8
    s_add_u32 s70, s70, s45
    s_lshl_b32 s45, s56, 5
    s_add_u32 s70, s70, s45
    s_add_u32 s70, s70, 16252928
    s_mov_b32 s50, 0x0000ffff
    s_mov_b32 s51, 0x0000ffff
    v_add_u32 v16, 32768, v16
    v_xor_b32_e64 v17, 32, v16
    s_waitcnt lgkmcnt(6)
    v_mfma_f32_16x16x32_bf16 v[64:67], v[48:51], v[152:155], v[64:67]
    ds_read_b64_tr_b16 v[32:33], v16 offset:0
    ds_read_b64_tr_b16 v[34:35], v16 offset:512
    v_mfma_f32_16x16x32_bf16 v[68:71], v[48:51], v[156:159], v[68:71]
    s_waitcnt lgkmcnt(6)
    v_mfma_f32_16x16x32_bf16 v[80:83], v[52:55], v[152:155], v[80:83]
    ds_read_b64_tr_b16 v[36:37], v16 offset:8192
    ds_read_b64_tr_b16 v[38:39], v16 offset:8704
    v_mfma_f32_16x16x32_bf16 v[84:87], v[52:55], v[156:159], v[84:87]
    v_permlane16_swap_b32 v160, v164
    v_permlane16_swap_b32 v161, v165
    v_permlane16_swap_b32 v162, v166
    v_permlane16_swap_b32 v163, v167
    s_lshl_b32 s85, s41, 5
    s_lshl_b32 s45, s40, 3
    s_add_u32 s85, s85, s45
    s_lshl_b32 s45, s38, 1
    s_add_u32 s85, s85, s45
    s_lshr_b32 s45, s36, 2
    s_add_u32 s85, s85, s45
    s_lshl_b32 s44, s85, 10
    buffer_load_dwordx4 v[104:107], v3, s[4:7], s44 offen
    buffer_load_dwordx4 v[108:111], v3, s[88:91], 0 offen
    s_waitcnt lgkmcnt(6)
    v_mfma_f32_16x16x32_bf16 v[72:75], v[56:59], v[152:155], v[72:75]
    ds_read_b64_tr_b16 v[40:41], v17 offset:0
    ds_read_b64_tr_b16 v[42:43], v17 offset:512
    v_mfma_f32_16x16x32_bf16 v[76:79], v[56:59], v[156:159], v[76:79]
    s_waitcnt lgkmcnt(6)
    v_mfma_f32_16x16x32_bf16 v[88:91], v[60:63], v[152:155], v[88:91]
    ds_read_b64_tr_b16 v[44:45], v17 offset:8192
    ds_read_b64_tr_b16 v[46:47], v17 offset:8704
    v_mfma_f32_16x16x32_bf16 v[92:95], v[60:63], v[156:159], v[92:95]
    s_waitcnt lgkmcnt(6)
    v_mfma_f32_16x16x32_bf16 v[64:67], v[32:35], v[160:163], v[64:67]
    ds_read_b64_tr_b16 v[48:49], v16 offset:4096
    ds_read_b64_tr_b16 v[50:51], v16 offset:4608
    v_mfma_f32_16x16x32_bf16 v[68:71], v[32:35], v[164:167], v[68:71]
    s_waitcnt lgkmcnt(6)
    v_mfma_f32_16x16x32_bf16 v[80:83], v[36:39], v[160:163], v[80:83]
    ds_read_b64_tr_b16 v[52:53], v16 offset:12288
    ds_read_b64_tr_b16 v[54:55], v16 offset:12800
    v_mfma_f32_16x16x32_bf16 v[84:87], v[36:39], v[164:167], v[84:87]
    v_permlane16_swap_b32 v168, v172
    v_permlane16_swap_b32 v169, v173
    v_permlane16_swap_b32 v170, v174
    v_permlane16_swap_b32 v171, v175
    s_waitcnt lgkmcnt(6)
    v_mfma_f32_16x16x32_bf16 v[72:75], v[40:43], v[160:163], v[72:75]
    ds_read_b64_tr_b16 v[56:57], v17 offset:4096
    ds_read_b64_tr_b16 v[58:59], v17 offset:4608
    v_mfma_f32_16x16x32_bf16 v[76:79], v[40:43], v[164:167], v[76:79]
    s_waitcnt lgkmcnt(6)
    v_mfma_f32_16x16x32_bf16 v[88:91], v[44:47], v[160:163], v[88:91]
    ds_read_b64_tr_b16 v[60:61], v17 offset:12288
    ds_read_b64_tr_b16 v[62:63], v17 offset:12800
    v_mfma_f32_16x16x32_bf16 v[92:95], v[44:47], v[164:167], v[92:95]
    s_waitcnt vmcnt(12)
    s_waitcnt vmcnt(2)
    s_barrier
    s_cmp_lg_u32 s36, 7
    s_cbranch_scc1 Lnf_13
    s_lshl_b32 s44, s40, 13
    s_lshl_b32 s45, s38, 11
    s_add_u32 s44, s44, s45
    s_lshl_b32 s45, s37, 7
    s_add_u32 s44, s44, s45
    s_add_u32 s44, s44, 15990784
    v_mov_b32 v18, s54
    v_mov_b32 v19, s55
    v_mov_b32_e64 v20, 0
    s_mov_b64 exec, 1
    buffer_store_dwordx2 v[18:19], v20, s[16:19], s44 offen sc1
    s_mov_b64 exec, -1
Lnf_13:
    s_waitcnt lgkmcnt(6)
    v_mfma_f32_16x16x32_bf16 v[64:67], v[48:51], v[168:171], v[64:67]
    ds_read_b64_tr_b16 v[32:33], v16 offset:16384
    ds_read_b64_tr_b16 v[34:35], v16 offset:16896
    v_mfma_f32_16x16x32_bf16 v[68:71], v[48:51], v[172:175], v[68:71]
    s_waitcnt lgkmcnt(6)
    v_mfma_f32_16x16x32_bf16 v[80:83], v[52:55], v[168:171], v[80:83]
    ds_read_b64_tr_b16 v[36:37], v16 offset:24576
    ds_read_b64_tr_b16 v[38:39], v16 offset:25088
    v_mfma_f32_16x16x32_bf16 v[84:87], v[52:55], v[172:175], v[84:87]
    v_permlane16_swap_b32 v176, v180
    v_permlane16_swap_b32 v177, v181
    v_permlane16_swap_b32 v178, v182
    v_permlane16_swap_b32 v179, v183
    s_waitcnt lgkmcnt(6)
    v_mfma_f32_16x16x32_bf16 v[72:75], v[56:59], v[168:171], v[72:75]
    ds_read_b64_tr_b16 v[40:41], v17 offset:16384
    ds_read_b64_tr_b16 v[42:43], v17 offset:16896
    v_mfma_f32_16x16x32_bf16 v[76:79], v[56:59], v[172:175], v[76:79]
    s_waitcnt lgkmcnt(6)
    v_mfma_f32_16x16x32_bf16 v[88:91], v[60:63], v[168:171], v[88:91]
    ds_read_b64_tr_b16 v[44:45], v17 offset:24576
    ds_read_b64_tr_b16 v[46:47], v17 offset:25088
    v_mfma_f32_16x16x32_bf16 v[92:95], v[60:63], v[172:175], v[92:95]
    s_waitcnt lgkmcnt(6)
    v_mfma_f32_16x16x32_bf16 v[64:67], v[32:35], v[176:179], v[64:67]
    ds_read_b64_tr_b16 v[48:49], v16 offset:20480
    ds_read_b64_tr_b16 v[50:51], v16 offset:20992
    v_mfma_f32_16x16x32_bf16 v[68:71], v[32:35], v[180:183], v[68:71]
    s_waitcnt lgkmcnt(6)
    v_mfma_f32_16x16x32_bf16 v[80:83], v[36:39], v[176:179], v[80:83]
    ds_read_b64_tr_b16 v[52:53], v16 offset:28672
    ds_read_b64_tr_b16 v[54:55], v16 offset:29184
    v_mfma_f32_16x16x32_bf16 v[84:87], v[36:39], v[180:183], v[84:87]
    v_permlane16_swap_b32 v184, v188
    v_permlane16_swap_b32 v185, v189
    v_permlane16_swap_b32 v186, v190
    v_permlane16_swap_b32 v187, v191
    s_waitcnt lgkmcnt(6)
    v_mfma_f32_16x16x32_bf16 v[72:75], v[40:43], v[176:179], v[72:75]
    ds_read_b64_tr_b16 v[56:57], v17 offset:20480
    ds_read_b64_tr_b16 v[58:59], v17 offset:20992
    v_mfma_f32_16x16x32_bf16 v[76:79], v[40:43], v[180:183], v[76:79]
    s_waitcnt lgkmcnt(6)
    v_mfma_f32_16x16x32_bf16 v[88:91], v[44:47], v[176:179], v[88:91]
    ds_read_b64_tr_b16 v[60:61], v17 offset:28672
    ds_read_b64_tr_b16 v[62:63], v17 offset:29184
    v_mfma_f32_16x16x32_bf16 v[92:95], v[44:47], v[180:183], v[92:95]
    v_add_u32 v16, 32768, v16
    v_xor_b32_e64 v17, 32, v16
    s_waitcnt lgkmcnt(6)
    v_mfma_f32_16x16x32_bf16 v[64:67], v[48:51], v[184:187], v[64:67]
    ds_read_b64_tr_b16 v[32:33], v16 offset:0
    ds_read_b64_tr_b16 v[34:35], v16 offset:512
    v_mfma_f32_16x16x32_bf16 v[68:71], v[48:51], v[188:191], v[68:71]
    s_waitcnt vmcnt(0)
    v_dot2_f32_bf16 v12, v104, v108, 0
    v_dot2_f32_bf16 v12, v105, v109, v12
    v_dot2_f32_bf16 v12, v106, v110, v12
    v_dot2_f32_bf16 v12, v107, v111, v12
    s_waitcnt lgkmcnt(6)
    v_mfma_f32_16x16x32_bf16 v[80:83], v[52:55], v[184:187], v[80:83]
    ds_read_b64_tr_b16 v[36:37], v16 offset:8192
    ds_read_b64_tr_b16 v[38:39], v16 offset:8704
    v_mfma_f32_16x16x32_bf16 v[84:87], v[52:55], v[188:191], v[84:87]
    v_permlane16_swap_b32 v192, v196
    v_permlane16_swap_b32 v193, v197
    v_permlane16_swap_b32 v194, v198
    v_permlane16_swap_b32 v195, v199
    v_add_f32_dpp v12, v12, v12 row_shr:1 row_mask:0xf bank_mask:0xf bound_ctrl:0
    s_waitcnt lgkmcnt(6)
    v_mfma_f32_16x16x32_bf16 v[72:75], v[56:59], v[184:187], v[72:75]
    ds_read_b64_tr_b16 v[40:41], v17 offset:0
    ds_read_b64_tr_b16 v[42:43], v17 offset:512
    v_mfma_f32_16x16x32_bf16 v[76:79], v[56:59], v[188:191], v[76:79]
    v_add_f32_dpp v12, v12, v12 row_shr:2 row_mask:0xf bank_mask:0xf bound_ctrl:0
    s_waitcnt lgkmcnt(6)
    v_mfma_f32_16x16x32_bf16 v[88:91], v[60:63], v[184:187], v[88:91]
    ds_read_b64_tr_b16 v[44:45], v17 offset:8192
    ds_read_b64_tr_b16 v[46:47], v17 offset:8704
    v_mfma_f32_16x16x32_bf16 v[92:95], v[60:63], v[188:191], v[92:95]
    v_add_f32_dpp v12, v12, v12 row_shr:4 row_mask:0xf bank_mask:0xf bound_ctrl:0
    s_waitcnt lgkmcnt(6)
    v_mfma_f32_16x16x32_bf16 v[64:67], v[32:35], v[192:195], v[64:67]
    ds_read_b64_tr_b16 v[48:49], v16 offset:4096
    ds_read_b64_tr_b16 v[50:51], v16 offset:4608
    v_mfma_f32_16x16x32_bf16 v[68:71], v[32:35], v[196:199], v[68:71]
    v_add_f32_dpp v12, v12, v12 row_shr:8 row_mask:0xf bank_mask:0xf bound_ctrl:0
    s_waitcnt lgkmcnt(6)
    v_mfma_f32_16x16x32_bf16 v[80:83], v[36:39], v[192:195], v[80:83]
    ds_read_b64_tr_b16 v[52:53], v16 offset:12288
    ds_read_b64_tr_b16 v[54:55], v16 offset:12800
    v_mfma_f32_16x16x32_bf16 v[84:87], v[36:39], v[196:199], v[84:87]
    v_permlane16_swap_b32 v200, v204
    v_permlane16_swap_b32 v201, v205
    v_permlane16_swap_b32 v202, v206
    v_permlane16_swap_b32 v203, v207
    v_add_f32_dpp v12, v12, v12 row_bcast:15 row_mask:0xa bank_mask:0xf
    s_waitcnt lgkmcnt(6)
    v_mfma_f32_16x16x32_bf16 v[72:75], v[40:43], v[192:195], v[72:75]
    ds_read_b64_tr_b16 v[56:57], v17 offset:4096
    ds_read_b64_tr_b16 v[58:59], v17 offset:4608
    v_mfma_f32_16x16x32_bf16 v[76:79], v[40:43], v[196:199], v[76:79]
    v_add_f32_dpp v12, v12, v12 row_bcast:31 row_mask:0xc bank_mask:0xf
    v_mul_f32 v12, 0xbfb8aa3b, v12
    v_exp_f32 v12, v12
    v_mov_b32 v13, 0
    s_waitcnt lgkmcnt(6)
    v_mfma_f32_16x16x32_bf16 v[88:91], v[44:47], v[192:195], v[88:91]
    ds_read_b64_tr_b16 v[60:61], v17 offset:12288
    ds_read_b64_tr_b16 v[62:63], v17 offset:12800
    v_mfma_f32_16x16x32_bf16 v[92:95], v[44:47], v[196:199], v[92:95]
    v_add_f32 v12, 1.0, v12
    v_rcp_f32_e64 v12, v12
    s_lshl_b32 s44, s85, 7
    s_add_u32 s85, s44, 15728640
    s_lshr_b32 s82, s46, 3
    s_lshl_b32 s82, s82, 13
    s_add_u32 s82, s82, 15990784
    s_bfe_u32 s45, s46, 0x10002
    s_lshl_b32 s45, s45, 11
    s_lshr_b32 s44, s47, 2
    s_lshl_b32 s44, s44, 7
    s_add_u32 s44, s44, s45
    v_lshlrev_b32 v21, 7, v2
    v_or_b32 v21, s45, v21
    v_add_u32 v21, 4096, v21
    s_mov_b32 exec_lo, 0
    v_mov_b32_e64 v21, s44
    s_mov_b32 exec_lo, -1
    buffer_load_dwordx2 v[26:27], v21, s[16:19], s82 offen sc1
    s_waitcnt lgkmcnt(6)
    v_mfma_f32_16x16x32_bf16 v[64:67], v[48:51], v[200:203], v[64:67]
    ds_read_b64_tr_b16 v[32:33], v16 offset:16384
    ds_read_b64_tr_b16 v[34:35], v16 offset:16896
    v_mfma_f32_16x16x32_bf16 v[68:71], v[48:51], v[204:207], v[68:71]
    s_mov_b32 exec_lo, 0
    s_brev_b32 exec_hi, 1
    buffer_store_dword v12, v13, s[16:19], s85 offen sc1
    s_mov_b64 exec, -1
    s_waitcnt lgkmcnt(6)
    v_mfma_f32_16x16x32_bf16 v[80:83], v[52:55], v[200:203], v[80:83]
    ds_read_b64_tr_b16 v[36:37], v16 offset:24576
    ds_read_b64_tr_b16 v[38:39], v16 offset:25088
    v_mfma_f32_16x16x32_bf16 v[84:87], v[52:55], v[204:207], v[84:87]
    v_permlane16_swap_b32 v208, v212
    v_permlane16_swap_b32 v209, v213
    v_permlane16_swap_b32 v210, v214
    v_permlane16_swap_b32 v211, v215
    s_waitcnt lgkmcnt(6)
    v_mfma_f32_16x16x32_bf16 v[72:75], v[56:59], v[200:203], v[72:75]
    ds_read_b64_tr_b16 v[40:41], v17 offset:16384
    ds_read_b64_tr_b16 v[42:43], v17 offset:16896
    v_mfma_f32_16x16x32_bf16 v[76:79], v[56:59], v[204:207], v[76:79]
    s_waitcnt lgkmcnt(6)
    v_mfma_f32_16x16x32_bf16 v[88:91], v[60:63], v[200:203], v[88:91]
    ds_read_b64_tr_b16 v[44:45], v17 offset:24576
    ds_read_b64_tr_b16 v[46:47], v17 offset:25088
    v_mfma_f32_16x16x32_bf16 v[92:95], v[60:63], v[204:207], v[92:95]
    s_barrier
    s_waitcnt lgkmcnt(6)
    v_mfma_f32_16x16x32_bf16 v[64:67], v[32:35], v[208:211], v[64:67]
    ds_read_b64_tr_b16 v[48:49], v16 offset:20480
    ds_read_b64_tr_b16 v[50:51], v16 offset:20992
    v_mfma_f32_16x16x32_bf16 v[68:71], v[32:35], v[212:215], v[68:71]
    s_waitcnt lgkmcnt(6)
    v_mfma_f32_16x16x32_bf16 v[80:83], v[36:39], v[208:211], v[80:83]
    ds_read_b64_tr_b16 v[52:53], v16 offset:28672
    ds_read_b64_tr_b16 v[54:55], v16 offset:29184
    v_mfma_f32_16x16x32_bf16 v[84:87], v[36:39], v[212:215], v[84:87]
    v_permlane16_swap_b32 v216, v220
    v_permlane16_swap_b32 v217, v221
    v_permlane16_swap_b32 v218, v222
    v_permlane16_swap_b32 v219, v223
    s_waitcnt lgkmcnt(6)
    v_mfma_f32_16x16x32_bf16 v[72:75], v[40:43], v[208:211], v[72:75]
    ds_read_b64_tr_b16 v[56:57], v17 offset:20480
    ds_read_b64_tr_b16 v[58:59], v17 offset:20992
    v_mfma_f32_16x16x32_bf16 v[76:79], v[40:43], v[212:215], v[76:79]
    s_waitcnt lgkmcnt(6)
    v_mfma_f32_16x16x32_bf16 v[88:91], v[44:47], v[208:211], v[88:91]
    ds_read_b64_tr_b16 v[60:61], v17 offset:28672
    ds_read_b64_tr_b16 v[62:63], v17 offset:29184
    v_mfma_f32_16x16x32_bf16 v[92:95], v[44:47], v[212:215], v[92:95]
    s_waitcnt vmcnt(1)
    s_mov_b32 s58, 0x40000
Lchk_14:
    v_cmp_eq_u64 vcc, s[54:55], v[26:27]
    s_cmp_eq_u64 vcc, exec
    s_cbranch_scc0 Lrt_15
Lok_16:
    s_lshl_b32 s44, s46, 16
    s_lshl_b32 s45, s47, 10
    s_add_u32 s44, s44, s45
    buffer_load_dwordx4 v[4:7], v3, s[16:19], s44 offen sc1
    s_add_u32 s44, s59, s81
    buffer_load_dwordx4 v[26:29], v3, s[16:19], s44 offen sc1
    v_add_u32 v16, 32768, v16
    v_xor_b32 v17, 32, v16
    s_lshl_b32 s68, s43, 1
    s_add_u32 m0, s68, 0
    s_add_u32 s68, s81, 0
    s_and_b32 s68, s68, 0x1ffff
    s_add_u32 s68, s68, s59
    s_waitcnt lgkmcnt(6)
    v_mfma_f32_16x16x32_bf16 v[64:67], v[48:51], v[216:219], v[64:67]
    ds_read_b64_tr_b16 v[32:33], v16 offset:0
    ds_read_b64_tr_b16 v[34:35], v16 offset:512
    v_mfma_f32_16x16x32_bf16 v[68:71], v[48:51], v[220:223], v[68:71]
    buffer_load_dwordx4 v30, s[16:19], s68 offen offset:0 sc1 lds
    v_lshrrev_b32 v18, 5, v2
    v_lshlrev_b32 v10, 12, v18
    v_bfe_u32 v19, v2, 2, 2
    v_lshl_add_u32 v10, v19, 10, v10
    s_waitcnt lgkmcnt(6)
    v_mfma_f32_16x16x32_bf16 v[80:83], v[52:55], v[216:219], v[80:83]
    ds_read_b64_tr_b16 v[36:37], v16 offset:8192
    ds_read_b64_tr_b16 v[38:39], v16 offset:8704
    v_mfma_f32_16x16x32_bf16 v[84:87], v[52:55], v[220:223], v[84:87]
    buffer_load_dwordx4 v30, s[16:19], s68 offen offset:1024 sc1 lds
    v_permlane16_swap_b32 v224, v228
    v_permlane16_swap_b32 v225, v229
    v_permlane16_swap_b32 v226, v230
    v_permlane16_swap_b32 v227, v231
    v_bfe_u32 v20, v2, 4, 1
    v_lshl_add_u32 v10, v20, 6, v10
    v_and_b32 v21, 3, v2
    v_lshl_add_u32 v10, v21, 4, v10
    s_lshl_b32 s44, s49, 7
    v_add_u32_e64 v10, s44, v10
    s_lshl_b32 s68, s43, 1
    s_add_u32 m0, s68, 16384
    s_add_u32 s68, s81, 16384
    s_and_b32 s68, s68, 0x1ffff
    s_add_u32 s68, s68, s59
    s_waitcnt lgkmcnt(6)
    v_mfma_f32_16x16x32_bf16 v[72:75], v[56:59], v[216:219], v[72:75]
    ds_read_b64_tr_b16 v[40:41], v17 offset:0
    ds_read_b64_tr_b16 v[42:43], v17 offset:512
    v_mfma_f32_16x16x32_bf16 v[76:79], v[56:59], v[220:223], v[76:79]
    buffer_load_dwordx4 v30, s[16:19], s68 offen offset:0 sc1 lds
    v_lshlrev_b32_e64 v22, 6, v19
    v_lshl_add_u32 v22, v20, 5, v22
    v_and_b32_e64 v21, 1, v2
    v_lshl_add_u32 v22, v21, 4, v22
    v_bfe_u32 v23, v2, 1, 1
    v_lshl_add_u32 v22, v23, 3, v22
    s_waitcnt lgkmcnt(6)
    v_mfma_f32_16x16x32_bf16 v[88:91], v[60:63], v[216:219], v[88:91]
    ds_read_b64_tr_b16 v[44:45], v17 offset:8192
    ds_read_b64_tr_b16 v[46:47], v17 offset:8704
    v_mfma_f32_16x16x32_bf16 v[92:95], v[60:63], v[220:223], v[92:95]
    buffer_load_dwordx4 v30, s[16:19], s68 offen offset:1024 sc1 lds
    v_lshl_add_u32 v22, v18, 9, v22
    s_lshl_b32 s68, s43, 1
    s_add_u32 m0, s68, 32768
    s_add_u32 s68, s81, 32768
    s_and_b32 s68, s68, 0x1ffff
    s_add_u32 s68, s68, s59
    s_waitcnt lgkmcnt(6)
    v_mfma_f32_16x16x32_bf16 v[64:67], v[32:35], v[224:227], v[64:67]
    ds_read_b64_tr_b16 v[48:49], v16 offset:4096
    ds_read_b64_tr_b16 v[50:51], v16 offset:4608
    v_mfma_f32_16x16x32_bf16 v[68:71], v[32:35], v[228:231], v[68:71]
    buffer_load_dwordx4 v30, s[16:19], s68 offen offset:0 sc1 lds
    s_and_b32 s44, s36, 2
    s_lshl_b32 s44, s44, 4
    s_and_b32 s45, s36, 4
    s_lshl_b32 s45, s45, 6
    s_or_b32 s44, s44, s45
    v_xor_b32_e64 v22, s44, v22
    s_lshl_b32 s42, s36, 12
    s_add_u32 s42, s42, 131072
    v_add_u32_e64 v11, s42, v22
    v_xor_b32 v15, 256, v11
    s_waitcnt lgkmcnt(6)
    v_mfma_f32_16x16x32_bf16 v[80:83], v[36:39], v[224:227], v[80:83]
    ds_read_b64_tr_b16 v[52:53], v16 offset:12288
    ds_read_b64_tr_b16 v[54:55], v16 offset:12800
    v_mfma_f32_16x16x32_bf16 v[84:87], v[36:39], v[228:231], v[84:87]
    buffer_load_dwordx4 v30, s[16:19], s68 offen offset:1024 sc1 lds
    v_permlane16_swap_b32 v232, v236
    v_permlane16_swap_b32 v233, v237
    v_permlane16_swap_b32 v234, v238
    v_permlane16_swap_b32 v235, v239
    s_and_b32 s44, s36, 1
    s_lshl_b32 s45, s48, 1
    s_add_u32 s75, s44, s45
    v_lshlrev_b32_e64 v21, 12, v21
    v_bfe_u32 v22, v2, 1, 3
    v_lshl_add_u32 v21, v22, 7, v21
    s_waitcnt lgkmcnt(6)
    v_mfma_f32_16x16x32_bf16 v[72:75], v[40:43], v[224:227], v[72:75]
    ds_read_b64_tr_b16 v[56:57], v17 offset:4096
    ds_read_b64_tr_b16 v[58:59], v17 offset:4608
    v_mfma_f32_16x16x32_bf16 v[76:79], v[40:43], v[228:231], v[76:79]
    s_lshl_b32 s80, s48, 13
    s_lshr_b32 s52, s36, 1
    s_lshl_b32 s44, s52, 10
    s_add_u32 s80, s80, s44
    s_add_u32 s80, s80, 16252928
    v_and_b32 v24, 15, v2
    v_lshl_add_u32 v24, v20, 5, v24
    v_lshl_add_u32 v24, v18, 4, v24
    v_lshlrev_b32 v24, 4, v24
    s_waitcnt lgkmcnt(6)
    v_mfma_f32_16x16x32_bf16 v[88:91], v[44:47], v[224:227], v[88:91]
    ds_read_b64_tr_b16 v[60:61], v17 offset:12288
    ds_read_b64_tr_b16 v[62:63], v17 offset:12800
    v_mfma_f32_16x16x32_bf16 v[92:95], v[44:47], v[228:231], v[92:95]
    s_cmp_lg_u32 s38, 3
    s_cselect_b64 s[86:87], -1, 0
    s_barrier
    s_waitcnt lgkmcnt(6)
    v_mfma_f32_16x16x32_bf16 v[64:67], v[48:51], v[232:235], v[64:67]
    ds_read_b64_tr_b16 v[32:33], v16 offset:16384
    ds_read_b64_tr_b16 v[34:35], v16 offset:16896
    v_mfma_f32_16x16x32_bf16 v[68:71], v[48:51], v[236:239], v[68:71]
    s_waitcnt vmcnt(6)
    v_mfma_f32_32x32x16_bf16 v[144:159], v[26:29], v[4:7], 0
    s_waitcnt lgkmcnt(6)
    v_mfma_f32_16x16x32_bf16 v[80:83], v[52:55], v[232:235], v[80:83]
    ds_read_b64_tr_b16 v[36:37], v16 offset:24576
    ds_read_b64_tr_b16 v[38:39], v16 offset:25088
    v_mfma_f32_16x16x32_bf16 v[84:87], v[52:55], v[236:239], v[84:87]
    v_permlane16_swap_b32 v240, v244
    v_permlane16_swap_b32 v241, v245
    v_permlane16_swap_b32 v242, v246
    v_permlane16_swap_b32 v243, v247
    v_mov_b32 v220, 0
    v_mov_b32 v221, 0
    v_mov_b32 v222, 0
    v_mov_b32 v223, 0
    v_and_b32 v18, 27, v2
    v_cmp_eq_u32 vcc, 16, v18
    v_mov_b32 v18, 0x3f803f80
    s_waitcnt lgkmcnt(6)
    v_mfma_f32_16x16x32_bf16 v[72:75], v[56:59], v[232:235], v[72:75]
    ds_read_b64_tr_b16 v[40:41], v17 offset:16384
    ds_read_b64_tr_b16 v[42:43], v17 offset:16896
    v_mfma_f32_16x16x32_bf16 v[76:79], v[56:59], v[236:239], v[76:79]
    v_max3_f32 v12, v144, v145, v146
    v_max3_f32 v12, v12, v147, v148
    v_max3_f32 v12, v12, v149, v150
    v_max3_f32 v12, v12, v151, v152
    v_max3_f32 v12, v12, v153, v154
    s_waitcnt lgkmcnt(6)
    v_mfma_f32_16x16x32_bf16 v[88:91], v[60:63], v[232:235], v[88:91]
    ds_read_b64_tr_b16 v[44:45], v17 offset:24576
    ds_read_b64_tr_b16 v[46:47], v17 offset:25088
    v_mfma_f32_16x16x32_bf16 v[92:95], v[60:63], v[236:239], v[92:95]
    v_max3_f32 v12, v12, v155, v156
    v_max3_f32 v12, v12, v157, v158
    v_max_f32 v12, v12, v159
    v_mov_b32_e64 v13, v12
    s_nop 1
    v_permlane32_swap_b32 v12, v13
    s_waitcnt lgkmcnt(6)
    v_mfma_f32_16x16x32_bf16 v[64:67], v[32:35], v[240:243], v[64:67]
    ds_read_b64_tr_b16 v[48:49], v16 offset:20480
    ds_read_b64_tr_b16 v[50:51], v16 offset:20992
    v_mfma_f32_16x16x32_bf16 v[68:71], v[32:35], v[244:247], v[68:71]
    v_max_f32 v12, v12, v13
    v_sub_f32 v128, 0, v12
    v_sub_f32 v129, 0, v12
    v_sub_f32 v130, 0, v12
    v_sub_f32 v131, 0, v12
    v_sub_f32_e64 v132, 0, v12
    s_waitcnt lgkmcnt(6)
    v_mfma_f32_16x16x32_bf16 v[80:83], v[36:39], v[240:243], v[80:83]
    ds_read_b64_tr_b16 v[52:53], v16 offset:28672
    ds_read_b64_tr_b16 v[54:55], v16 offset:29184
    v_mfma_f32_16x16x32_bf16 v[84:87], v[36:39], v[244:247], v[84:87]
    v_permlane16_swap_b32 v248, v252
    v_permlane16_swap_b32 v249, v253
    v_permlane16_swap_b32 v250, v254
    v_permlane16_swap_b32 v251, v255
    v_sub_f32 v133, 0, v12
    v_sub_f32 v134, 0, v12
    v_sub_f32 v135, 0, v12
    v_sub_f32 v136, 0, v12
    v_sub_f32 v137, 0, v12
    v_sub_f32_e64 v138, 0, v12
    s_waitcnt lgkmcnt(6)
    v_mfma_f32_16x16x32_bf16 v[72:75], v[40:43], v[240:243], v[72:75]
    ds_read_b64_tr_b16 v[56:57], v17 offset:20480
    ds_read_b64_tr_b16 v[58:59], v17 offset:20992
    v_mfma_f32_16x16x32_bf16 v[76:79], v[40:43], v[244:247], v[76:79]
    v_sub_f32 v139, 0, v12
    v_sub_f32 v140, 0, v12
    v_sub_f32 v141, 0, v12
    v_sub_f32 v142, 0, v12
    v_sub_f32 v143, 0, v12
    s_waitcnt lgkmcnt(6)
    v_mfma_f32_16x16x32_bf16 v[88:91], v[44:47], v[240:243], v[88:91]
    ds_read_b64_tr_b16 v[60:61], v17 offset:28672
    ds_read_b64_tr_b16 v[62:63], v17 offset:29184
    v_mfma_f32_16x16x32_bf16 v[92:95], v[44:47], v[244:247], v[92:95]
    v_cndmask_b32 v200, v220, v18, vcc
    v_cndmask_b32 v201, v220, v18, vcc
    v_cndmask_b32 v202, v220, v18, vcc
    v_cndmask_b32 v203, v220, v18, vcc
    v_mfma_f32_32x32x16_bf16 v[144:159], v[26:29], v[4:7], v[128:143]
    s_waitcnt lgkmcnt(6)
    v_mfma_f32_16x16x32_bf16 v[64:67], v[48:51], v[248:251], v[64:67]
    v_mfma_f32_16x16x32_bf16 v[68:71], v[48:51], v[252:255], v[68:71]
    v_cndmask_b32 v204, v220, v18, vcc
    v_cndmask_b32 v205, v220, v18, vcc
    v_cndmask_b32 v206, v220, v18, vcc
    v_cndmask_b32 v207, v220, v18, vcc
    v_mov_b32_e64 v8, v3
    s_waitcnt lgkmcnt(4)
    v_mfma_f32_16x16x32_bf16 v[80:83], v[52:55], v[248:251], v[80:83]
    v_mfma_f32_16x16x32_bf16 v[84:87], v[52:55], v[252:255], v[84:87]
    v_lshrrev_b32 v19, 5, v2
    v_lshlrev_b32 v9, 8, v19
    v_and_b32_e64 v19, 15, v2
    v_lshl_add_u32 v9, v19, 4, v9
    v_add_u32 v9, 1024, v9
    s_waitcnt lgkmcnt(0)
    s_waitcnt vmcnt(2)
    s_barrier
    v_mfma_f32_16x16x32_bf16 v[72:75], v[56:59], v[248:251], v[72:75]
    ds_read_b128 v[196:199], v3 offset:2048
    v_mfma_f32_16x16x32_bf16 v[76:79], v[56:59], v[252:255], v[76:79]
    v_cndmask_b32 v208, v220, v18, vcc
    v_cndmask_b32 v209, v220, v18, vcc
    v_cndmask_b32 v210, v220, v18, vcc
    v_cndmask_b32 v211, v220, v18, vcc
    v_mfma_f32_16x16x32_bf16 v[88:91], v[60:63], v[248:251], v[88:91]
    v_mfma_f32_16x16x32_bf16 v[92:95], v[60:63], v[252:255], v[92:95]
    v_cndmask_b32 v212, v220, v18, vcc
    v_cndmask_b32 v213, v220, v18, vcc
    v_cndmask_b32 v214, v220, v18, vcc
    v_cndmask_b32 v215, v220, v18, vcc
    s_mov_b64 exec, s[50:51]
    ds_read_b128 v[200:203], v9
    ds_read_b128 v[204:207], v9 offset:512
    s_mov_b64 exec, -1
    s_nop 9
    v_pk_mul_f32 v[64:65], v[64:65], v[80:81]
    v_pk_mul_f32 v[66:67], v[66:67], v[82:83]
    v_pk_mul_f32 v[68:69], v[68:69], v[84:85]
    v_pk_mul_f32 v[70:71], v[70:71], v[86:87]
    v_cvt_pk_bf16_f32 v32, v64, v65
    v_cvt_pk_bf16_f32 v33, v66, v67
    v_cvt_pk_bf16_f32 v34, v68, v69
    v_cvt_pk_bf16_f32 v35, v70, v71
    s_nop 1
    v_permlane32_swap_b32 v32, v34
    v_permlane32_swap_b32 v33, v35
    v_pk_mul_f32 v[72:73], v[72:73], v[88:89]
    v_pk_mul_f32 v[74:75], v[74:75], v[90:91]
    v_pk_mul_f32 v[76:77], v[76:77], v[92:93]
    v_pk_mul_f32 v[78:79], v[78:79], v[94:95]
    v_cvt_pk_bf16_f32 v36, v72, v73
    v_cvt_pk_bf16_f32 v37, v74, v75
    v_cvt_pk_bf16_f32 v38, v76, v77
    v_cvt_pk_bf16_f32 v39, v78, v79
    s_nop 1
    v_permlane32_swap_b32 v36, v38
    v_permlane32_swap_b32 v37, v39
L_att:
    s_setprio 3
    v_exp_f32_e64 v144, v144
    s_waitcnt lgkmcnt(0)
    v_mfma_f32_32x32x16_bf16 v[160:175], v[196:199], v[4:7], v[128:143]
    ds_read_b128 v[192:195], v8 offset:4096
    v_exp_f32 v145, v145
    v_exp_f32 v146, v146
    v_exp_f32 v147, v147
    v_exp_f32 v148, v148
    v_mfma_f32_32x32x16_bf16 v[176:191], v[212:215], v[220:223], 0
    v_exp_f32 v149, v149
    s_mov_b64 exec, s[50:51]
    ds_read_b128 v[208:211], v9 offset:2048
    ds_read_b128 v[212:215], v9 offset:2560
    s_mov_b64 exec, -1
    v_exp_f32 v150, v150
    v_exp_f32_e64 v151, v151
    buffer_store_dwordx4 v[32:35], v24, s[16:19], s72 offen offset:0 sc1
    v_exp_f32_e64 v152, v152
    v_cvt_pk_bf16_f32 v216, v144, v145
    v_cvt_pk_bf16_f32 v217, v146, v147
    v_cvt_pk_bf16_f32 v218, v148, v149
    v_cvt_pk_bf16_f32 v219, v150, v151
    v_exp_f32 v153, v153
    v_exp_f32 v154, v154
    v_mfma_f32_32x32x16_bf16 v[176:191], v[200:203], v[216:219], v[176:191]
    v_exp_f32 v155, v155
    v_exp_f32 v156, v156
    v_exp_f32 v157, v157
    v_exp_f32 v158, v158
    v_exp_f32_e64 v159, v159
    buffer_store_dwordx4 v[36:39], v24, s[16:19], s72 offen offset:1024 sc1
    v_cvt_pk_bf16_f32 v220, v152, v153
    v_cvt_pk_bf16_f32 v221, v154, v155
    v_cvt_pk_bf16_f32 v222, v156, v157
    v_cvt_pk_bf16_f32 v223, v158, v159
    v_exp_f32 v160, v160
    s_waitcnt lgkmcnt(0)
    v_mfma_f32_32x32x16_bf16 v[144:159], v[192:195], v[4:7], v[128:143]
    ds_read_b128 v[196:199], v8 offset:6144
    v_exp_f32 v161, v161
    v_exp_f32 v162, v162
    v_exp_f32 v163, v163
    v_exp_f32 v164, v164
    v_mfma_f32_32x32x16_bf16 v[176:191], v[204:207], v[220:223], v[176:191]
    v_exp_f32 v165, v165
    s_mov_b64 exec, s[50:51]
    ds_read_b128 v[200:203], v9 offset:4096
    ds_read_b128 v[204:207], v9 offset:4608
    s_mov_b64 exec, -1
    v_exp_f32 v166, v166
    v_exp_f32 v167, v167
    s_mov_b64 exec, s[86:87]
    buffer_store_dwordx4 v[40:43], v24, s[16:19], s72 offen offset:2048 sc1
    s_mov_b64 exec, -1
    v_exp_f32 v168, v168
    v_cvt_pk_bf16_f32 v216, v160, v161
    v_cvt_pk_bf16_f32 v217, v162, v163
    v_cvt_pk_bf16_f32 v218, v164, v165
    v_cvt_pk_bf16_f32 v219, v166, v167
    v_exp_f32 v169, v169
    v_exp_f32 v170, v170
    v_mfma_f32_32x32x16_bf16 v[176:191], v[208:211], v[216:219], v[176:191]
    v_exp_f32 v171, v171
    v_exp_f32 v172, v172
    v_exp_f32 v173, v173
    v_exp_f32 v174, v174
    v_exp_f32 v175, v175
    s_mov_b64 exec, s[86:87]
    buffer_store_dwordx4 v[44:47], v24, s[16:19], s72 offen offset:3072 sc1
    s_mov_b64 exec, -1
    v_cvt_pk_bf16_f32 v220, v168, v169
    v_cvt_pk_bf16_f32 v221, v170, v171
    v_cvt_pk_bf16_f32 v222, v172, v173
    v_cvt_pk_bf16_f32 v223, v174, v175
    v_exp_f32 v144, v144
    s_waitcnt lgkmcnt(0)
    s_setprio 2
    v_mfma_f32_32x32x16_bf16 v[160:175], v[196:199], v[4:7], v[128:143]
    ds_read_b128 v[192:195], v8 offset:8192
    v_exp_f32 v145, v145
    v_exp_f32 v146, v146
    v_exp_f32 v147, v147
    v_exp_f32 v148, v148
    v_mfma_f32_32x32x16_bf16 v[176:191], v[212:215], v[220:223], v[176:191]
    v_exp_f32 v149, v149
    s_mov_b64 exec, s[50:51]
    ds_read_b128 v[208:211], v9 offset:6144
    ds_read_b128 v[212:215], v9 offset:6656
    s_mov_b64 exec, -1
    v_exp_f32 v150, v150
    v_exp_f32 v151, v151
    v_exp_f32 v152, v152
    v_cvt_pk_bf16_f32 v216, v144, v145
    v_cvt_pk_bf16_f32 v217, v146, v147
    v_cvt_pk_bf16_f32 v218, v148, v149
    v_cvt_pk_bf16_f32 v219, v150, v151
    v_exp_f32 v153, v153
    v_exp_f32 v154, v154
    v_mfma_f32_32x32x16_bf16 v[176:191], v[200:203], v[216:219], v[176:191]
    v_exp_f32 v155, v155
    v_exp_f32 v156, v156
    v_exp_f32 v157, v157
    v_exp_f32 v158, v158
    v_exp_f32_e64 v159, v159
    v_cvt_pk_bf16_f32 v220, v152, v153
    v_cvt_pk_bf16_f32 v221, v154, v155
    v_cvt_pk_bf16_f32 v222, v156, v157
    v_cvt_pk_bf16_f32 v223, v158, v159
    v_exp_f32_e64 v160, v160
    s_waitcnt lgkmcnt(0)
    s_setprio 1
    v_mfma_f32_32x32x16_bf16 v[144:159], v[192:195], v[4:7], v[128:143]
    ds_read_b128 v[196:199], v8 offset:10240
    v_exp_f32 v161, v161
    v_exp_f32 v162, v162
    v_exp_f32 v163, v163
    v_exp_f32 v164, v164
    v_mfma_f32_32x32x16_bf16 v[176:191], v[204:207], v[220:223], v[176:191]
    v_exp_f32 v165, v165
    s_mov_b64 exec, s[50:51]
    ds_read_b128 v[200:203], v9 offset:8192
    ds_read_b128 v[204:207], v9 offset:8704
    s_mov_b64 exec, -1
    s_lshl_b32 s45, s43, 1
    s_add_u32 m0, s45, 49152
    s_add_u32 s44, s81, 49152
    s_and_b32 s44, s44, 0x1ffff
    s_add_u32 s44, s44, s59
    buffer_load_dwordx4 v30, s[16:19], s44 offen sc1 lds
    buffer_load_dwordx4 v30, s[16:19], s44 offen offset:1024 sc1 lds
    v_exp_f32 v166, v166
    v_exp_f32 v167, v167
    v_exp_f32 v168, v168
    v_cvt_pk_bf16_f32 v216, v160, v161
    v_cvt_pk_bf16_f32 v217, v162, v163
    v_cvt_pk_bf16_f32 v218, v164, v165
    v_cvt_pk_bf16_f32 v219, v166, v167
    v_exp_f32 v169, v169
    v_exp_f32 v170, v170
    v_mfma_f32_32x32x16_bf16 v[176:191], v[208:211], v[216:219], v[176:191]
    v_exp_f32 v171, v171
    v_exp_f32 v172, v172
    v_exp_f32 v173, v173
    v_exp_f32 v174, v174
    v_exp_f32_e64 v175, v175
    v_cvt_pk_bf16_f32 v220, v168, v169
    v_cvt_pk_bf16_f32 v221, v170, v171
    v_cvt_pk_bf16_f32 v222, v172, v173
    v_cvt_pk_bf16_f32 v223, v174, v175
    v_exp_f32 v144, v144
    s_waitcnt lgkmcnt(0)
    v_mfma_f32_32x32x16_bf16 v[160:175], v[196:199], v[4:7], v[128:143]
    ds_read_b128 v[192:195], v8 offset:12288
    v_exp_f32 v145, v145
    v_exp_f32 v146, v146
    v_exp_f32 v147, v147
    v_exp_f32 v148, v148
    v_mfma_f32_32x32x16_bf16 v[176:191], v[212:215], v[220:223], v[176:191]
    v_exp_f32 v149, v149
    s_mov_b64 exec, s[50:51]
    ds_read_b128 v[208:211], v9 offset:10240
    ds_read_b128 v[212:215], v9 offset:10752
    s_mov_b64 exec, -1
    s_lshl_b32 s45, s43, 1
    s_add_u32 m0, s45, 65536
    s_add_u32 s44, s81, 65536
    s_and_b32 s44, s44, 0x1ffff
    s_add_u32 s44, s44, s59
    buffer_load_dwordx4 v30, s[16:19], s44 offen sc1 lds
    buffer_load_dwordx4 v30, s[16:19], s44 offen offset:1024 sc1 lds
    s_waitcnt vmcnt(4)
    v_mov_b32 v18, s54
    v_mov_b32 v19, s55
    v_mov_b32 v20, 0
    s_mov_b64 exec, 1
    buffer_store_dwordx2 v[18:19], v20, s[16:19], s70 offen sc1
    s_mov_b64 exec, -1
    s_mul_i32 s44, s36, 14336
    s_add_u32 s44, s44, 8388608
    s_mul_i32 s70, s75, 114688
    s_add_u32 s70, s70, s44
    s_xor_b32 s71, s75, 1
    s_mul_i32 s71, s71, 114688
    s_add_u32 s71, s71, s44
    s_mul_i32 s72, s36, 229376
    v_exp_f32 v150, v150
    v_exp_f32 v151, v151
    v_exp_f32_e64 v152, v152
    v_cvt_pk_bf16_f32 v216, v144, v145
    v_cvt_pk_bf16_f32 v217, v146, v147
    v_cvt_pk_bf16_f32 v218, v148, v149
    v_cvt_pk_bf16_f32 v219, v150, v151
    v_exp_f32 v153, v153
    v_exp_f32 v154, v154
    v_mfma_f32_32x32x16_bf16 v[176:191], v[200:203], v[216:219], v[176:191]
    v_exp_f32 v155, v155
    v_exp_f32 v156, v156
    v_exp_f32 v157, v157
    v_exp_f32 v158, v158
    v_exp_f32_e64 v159, v159
    v_cvt_pk_bf16_f32 v220, v152, v153
    v_cvt_pk_bf16_f32 v221, v154, v155
    v_cvt_pk_bf16_f32 v222, v156, v157
    v_cvt_pk_bf16_f32 v223, v158, v159
    v_exp_f32_e64 v160, v160
    s_waitcnt lgkmcnt(0)
    s_setprio 0
    v_mfma_f32_32x32x16_bf16 v[144:159], v[192:195], v[4:7], v[128:143]
    ds_read_b128 v[196:199], v8 offset:14336
    v_exp_f32 v161, v161
    v_exp_f32 v162, v162
    v_exp_f32 v163, v163
    v_exp_f32 v164, v164
    v_mfma_f32_32x32x16_bf16 v[176:191], v[204:207], v[220:223], v[176:191]
    v_exp_f32 v165, v165
    s_mov_b64 exec, s[50:51]
    ds_read_b128 v[200:203], v9 offset:12288
    ds_read_b128 v[204:207], v9 offset:12800
    s_mov_b64 exec, -1
    s_lshl_b32 s45, s43, 1
    s_add_u32 m0, s45, 81920
    s_add_u32 s44, s81, 81920
    s_and_b32 s44, s44, 0x1ffff
    s_add_u32 s44, s44, s59
    buffer_load_dwordx4 v30, s[16:19], s44 offen sc1 lds
    buffer_load_dwordx4 v30, s[16:19], s44 offen offset:1024 sc1 lds
    v_exp_f32 v166, v166
    v_exp_f32 v167, v167
    v_exp_f32 v168, v168
    v_cvt_pk_bf16_f32 v216, v160, v161
    v_cvt_pk_bf16_f32 v217, v162, v163
    v_cvt_pk_bf16_f32 v218, v164, v165
    v_cvt_pk_bf16_f32 v219, v166, v167
    v_exp_f32 v169, v169
    v_exp_f32 v170, v170
    v_mfma_f32_32x32x16_bf16 v[176:191], v[208:211], v[216:219], v[176:191]
    v_exp_f32 v171, v171
    v_exp_f32 v172, v172
    v_exp_f32 v173, v173
    v_exp_f32 v174, v174
    v_exp_f32_e64 v175, v175
    v_cvt_pk_bf16_f32 v220, v168, v169
    v_cvt_pk_bf16_f32 v221, v170, v171
    v_cvt_pk_bf16_f32 v222, v172, v173
    v_cvt_pk_bf16_f32 v223, v174, v175
    v_exp_f32_e64 v144, v144
    s_waitcnt lgkmcnt(0)
    s_setprio 3
    v_mfma_f32_32x32x16_bf16 v[160:175], v[196:199], v[4:7], v[128:143]
    ds_read_b128 v[192:195], v8 offset:16384
    v_exp_f32 v145, v145
    v_exp_f32 v146, v146
    v_exp_f32 v147, v147
    v_exp_f32 v148, v148
    v_mfma_f32_32x32x16_bf16 v[176:191], v[212:215], v[220:223], v[176:191]
    v_exp_f32 v149, v149
    s_mov_b64 exec, s[50:51]
    ds_read_b128 v[208:211], v9 offset:14336
    ds_read_b128 v[212:215], v9 offset:14848
    s_mov_b64 exec, -1
    s_lshl_b32 s45, s43, 1
    s_add_u32 m0, s45, 98304
    s_add_u32 s44, s81, 98304
    s_and_b32 s44, s44, 0x1ffff
    s_add_u32 s44, s44, s59
    buffer_load_dwordx4 v30, s[16:19], s44 offen sc1 lds
    buffer_load_dwordx4 v30, s[16:19], s44 offen offset:1024 sc1 lds
    s_lshl_b32 s84, s47, 15
    s_lshl_b32 s45, s46, 10
    s_add_u32 s84, s84, s45
    s_add_u32 s84, s84, 6291456
    v_mov_b32 v22, -1
    v_mov_b32 v23, -1
    v_mov_b32 v24, -1
    v_mov_b32 v25, -1
    buffer_store_dwordx4 v[22:25], v3, s[16:19], s84 offen sc1
    v_exp_f32 v150, v150
    v_exp_f32 v151, v151
    v_exp_f32_e64 v152, v152
    v_cvt_pk_bf16_f32 v216, v144, v145
    v_cvt_pk_bf16_f32 v217, v146, v147
    v_cvt_pk_bf16_f32 v218, v148, v149
    v_cvt_pk_bf16_f32 v219, v150, v151
    v_exp_f32 v153, v153
    v_exp_f32 v154, v154
    v_mfma_f32_32x32x16_bf16 v[176:191], v[200:203], v[216:219], v[176:191]
    v_exp_f32 v155, v155
    v_exp_f32 v156, v156
    v_exp_f32 v157, v157
    v_exp_f32 v158, v158
    v_exp_f32_e64 v159, v159
    v_cvt_pk_bf16_f32 v220, v152, v153
    v_cvt_pk_bf16_f32 v221, v154, v155
    v_cvt_pk_bf16_f32 v222, v156, v157
    v_cvt_pk_bf16_f32 v223, v158, v159
    v_exp_f32 v160, v160
    s_waitcnt lgkmcnt(0)
    v_mfma_f32_32x32x16_bf16 v[144:159], v[192:195], v[4:7], v[128:143]
    ds_read_b128 v[196:199], v8 offset:18432
    v_exp_f32 v161, v161
    v_exp_f32 v162, v162
    v_exp_f32 v163, v163
    v_exp_f32 v164, v164
    v_mfma_f32_32x32x16_bf16 v[176:191], v[204:207], v[220:223], v[176:191]
    v_exp_f32 v165, v165
    s_mov_b64 exec, s[50:51]
    ds_read_b128 v[200:203], v9 offset:16384
    ds_read_b128 v[204:207], v9 offset:16896
    s_mov_b64 exec, -1
    s_lshl_b32 s45, s43, 1
    s_add_u32 m0, s45, 114688
    s_add_u32 s44, s81, 114688
    s_and_b32 s44, s44, 0x1ffff
    s_add_u32 s44, s44, s59
    buffer_load_dwordx4 v30, s[16:19], s44 offen sc1 lds
    buffer_load_dwordx4 v30, s[16:19], s44 offen offset:1024 sc1 lds
    v_exp_f32 v166, v166
    v_exp_f32 v167, v167
    v_exp_f32 v168, v168
    v_cvt_pk_bf16_f32 v216, v160, v161
    v_cvt_pk_bf16_f32 v217, v162, v163
    v_cvt_pk_bf16_f32 v218, v164, v165
    v_cvt_pk_bf16_f32 v219, v166, v167
    v_exp_f32 v169, v169
    v_exp_f32 v170, v170
    v_mfma_f32_32x32x16_bf16 v[176:191], v[208:211], v[216:219], v[176:191]
    v_exp_f32 v171, v171
    v_exp_f32 v172, v172
    v_exp_f32 v173, v173
    v_exp_f32 v174, v174
    v_exp_f32_e64 v175, v175
    v_cvt_pk_bf16_f32 v220, v168, v169
    v_cvt_pk_bf16_f32 v221, v170, v171
    v_cvt_pk_bf16_f32 v222, v172, v173
    v_cvt_pk_bf16_f32 v223, v174, v175
    v_exp_f32_e64 v144, v144
    s_waitcnt lgkmcnt(0)
    s_setprio 2
    v_mfma_f32_32x32x16_bf16 v[160:175], v[196:199], v[4:7], v[128:143]
    ds_read_b128 v[192:195], v8 offset:20480
    v_exp_f32 v145, v145
    v_exp_f32 v146, v146
    v_exp_f32 v147, v147
    v_exp_f32 v148, v148
    v_mfma_f32_32x32x16_bf16 v[176:191], v[212:215], v[220:223], v[176:191]
    v_exp_f32 v149, v149
    s_mov_b64 exec, s[50:51]
    ds_read_b128 v[208:211], v9 offset:18432
    ds_read_b128 v[212:215], v9 offset:18944
    s_mov_b64 exec, -1
    v_exp_f32 v150, v150
    v_exp_f32 v151, v151
    v_exp_f32 v152, v152
    v_cvt_pk_bf16_f32 v216, v144, v145
    v_cvt_pk_bf16_f32 v217, v146, v147
    v_cvt_pk_bf16_f32 v218, v148, v149
    v_cvt_pk_bf16_f32 v219, v150, v151
    v_exp_f32 v153, v153
    v_exp_f32 v154, v154
    v_mfma_f32_32x32x16_bf16 v[176:191], v[200:203], v[216:219], v[176:191]
    v_exp_f32 v155, v155
    v_exp_f32 v156, v156
    v_exp_f32 v157, v157
    v_exp_f32 v158, v158
    v_exp_f32_e64 v159, v159
    v_cvt_pk_bf16_f32 v220, v152, v153
    v_cvt_pk_bf16_f32 v221, v154, v155
    v_cvt_pk_bf16_f32 v222, v156, v157
    v_cvt_pk_bf16_f32 v223, v158, v159
    v_exp_f32 v160, v160
    s_waitcnt lgkmcnt(0)
    v_mfma_f32_32x32x16_bf16 v[144:159], v[192:195], v[4:7], v[128:143]
    ds_read_b128 v[196:199], v8 offset:22528
    v_exp_f32 v161, v161
    v_exp_f32 v162, v162
    v_exp_f32 v163, v163
    v_exp_f32 v164, v164
    v_mfma_f32_32x32x16_bf16 v[176:191], v[204:207], v[220:223], v[176:191]
    v_exp_f32 v165, v165
    s_mov_b64 exec, s[50:51]
    ds_read_b128 v[200:203], v9 offset:20480
    ds_read_b128 v[204:207], v9 offset:20992
    s_mov_b64 exec, -1
    v_exp_f32 v166, v166
    v_exp_f32 v167, v167
    v_exp_f32 v168, v168
    v_cvt_pk_bf16_f32 v216, v160, v161
    v_cvt_pk_bf16_f32 v217, v162, v163
    v_cvt_pk_bf16_f32 v218, v164, v165
    v_cvt_pk_bf16_f32 v219, v166, v167
    v_exp_f32 v169, v169
    v_exp_f32 v170, v170
    v_mfma_f32_32x32x16_bf16 v[176:191], v[208:211], v[216:219], v[176:191]
    v_exp_f32 v171, v171
    v_exp_f32 v172, v172
    v_exp_f32 v173, v173
    v_exp_f32 v174, v174
    v_exp_f32_e64 v175, v175
    v_cvt_pk_bf16_f32 v220, v168, v169
    v_cvt_pk_bf16_f32 v221, v170, v171
    v_cvt_pk_bf16_f32 v222, v172, v173
    v_cvt_pk_bf16_f32 v223, v174, v175
    v_exp_f32_e64 v144, v144
    s_waitcnt lgkmcnt(0)
    s_setprio 1
    v_mfma_f32_32x32x16_bf16 v[160:175], v[196:199], v[4:7], v[128:143]
    ds_read_b128 v[192:195], v8 offset:24576
    v_exp_f32 v145, v145
    v_exp_f32 v146, v146
    v_exp_f32 v147, v147
    v_exp_f32 v148, v148
    v_mfma_f32_32x32x16_bf16 v[176:191], v[212:215], v[220:223], v[176:191]
    v_exp_f32 v149, v149
    s_mov_b64 exec, s[50:51]
    ds_read_b128 v[208:211], v9 offset:22528
    ds_read_b128 v[212:215], v9 offset:23040
    s_mov_b64 exec, -1
    v_exp_f32 v150, v150
    v_exp_f32 v151, v151
    v_exp_f32 v152, v152
    v_cvt_pk_bf16_f32 v216, v144, v145
    v_cvt_pk_bf16_f32 v217, v146, v147
    v_cvt_pk_bf16_f32 v218, v148, v149
    v_cvt_pk_bf16_f32 v219, v150, v151
    v_exp_f32 v153, v153
    v_exp_f32 v154, v154
    v_mfma_f32_32x32x16_bf16 v[176:191], v[200:203], v[216:219], v[176:191]
    v_exp_f32 v155, v155
    v_exp_f32 v156, v156
    v_exp_f32 v157, v157
    v_exp_f32 v158, v158
    v_exp_f32_e64 v159, v159
    v_cvt_pk_bf16_f32 v220, v152, v153
    v_cvt_pk_bf16_f32 v221, v154, v155
    v_cvt_pk_bf16_f32 v222, v156, v157
    v_cvt_pk_bf16_f32 v223, v158, v159
    v_exp_f32 v160, v160
    s_waitcnt lgkmcnt(0)
    v_mfma_f32_32x32x16_bf16 v[144:159], v[192:195], v[4:7], v[128:143]
    ds_read_b128 v[196:199], v8 offset:26624
    v_exp_f32 v161, v161
    v_exp_f32 v162, v162
    v_exp_f32 v163, v163
    v_exp_f32 v164, v164
    v_mfma_f32_32x32x16_bf16 v[176:191], v[204:207], v[220:223], v[176:191]
    v_exp_f32 v165, v165
    s_mov_b64 exec, s[50:51]
    ds_read_b128 v[200:203], v9 offset:24576
    ds_read_b128 v[204:207], v9 offset:25088
    s_mov_b64 exec, -1
    v_exp_f32 v166, v166
    v_exp_f32 v167, v167
    v_exp_f32 v168, v168
    v_cvt_pk_bf16_f32 v216, v160, v161
    v_cvt_pk_bf16_f32 v217, v162, v163
    v_cvt_pk_bf16_f32 v218, v164, v165
    v_cvt_pk_bf16_f32 v219, v166, v167
    v_exp_f32 v169, v169
    v_exp_f32 v170, v170
    v_mfma_f32_32x32x16_bf16 v[176:191], v[208:211], v[216:219], v[176:191]
    v_exp_f32 v171, v171
    v_exp_f32 v172, v172
    v_exp_f32 v173, v173
    v_exp_f32 v174, v174
    v_exp_f32_e64 v175, v175
    v_cvt_pk_bf16_f32 v220, v168, v169
    v_cvt_pk_bf16_f32 v221, v170, v171
    v_cvt_pk_bf16_f32 v222, v172, v173
    v_cvt_pk_bf16_f32 v223, v174, v175
    v_exp_f32_e64 v144, v144
    s_waitcnt lgkmcnt(0)
    s_setprio 0
    v_mfma_f32_32x32x16_bf16 v[160:175], v[196:199], v[4:7], v[128:143]
    ds_read_b128 v[192:195], v8 offset:28672
    v_exp_f32 v145, v145
    v_exp_f32 v146, v146
    v_exp_f32 v147, v147
    v_exp_f32 v148, v148
    v_mfma_f32_32x32x16_bf16 v[176:191], v[212:215], v[220:223], v[176:191]
    v_exp_f32 v149, v149
    s_mov_b64 exec, s[50:51]
    ds_read_b128 v[208:211], v9 offset:26624
    ds_read_b128 v[212:215], v9 offset:27136
    s_mov_b64 exec, -1
    buffer_load_dwordx2 v[26:27], v21, s[16:19], s80 offen sc1
    v_exp_f32 v150, v150
    v_exp_f32 v151, v151
    v_exp_f32 v152, v152
    v_cvt_pk_bf16_f32 v216, v144, v145
    v_cvt_pk_bf16_f32 v217, v146, v147
    v_cvt_pk_bf16_f32 v218, v148, v149
    v_cvt_pk_bf16_f32 v219, v150, v151
    v_exp_f32 v153, v153
    v_exp_f32 v154, v154
    v_mfma_f32_32x32x16_bf16 v[176:191], v[200:203], v[216:219], v[176:191]
    v_exp_f32 v155, v155
    v_exp_f32 v156, v156
    v_exp_f32 v157, v157
    v_exp_f32 v158, v158
    v_exp_f32_e64 v159, v159
    v_cvt_pk_bf16_f32 v220, v152, v153
    v_cvt_pk_bf16_f32 v221, v154, v155
    v_cvt_pk_bf16_f32 v222, v156, v157
    v_cvt_pk_bf16_f32 v223, v158, v159
    v_exp_f32 v160, v160
    s_waitcnt lgkmcnt(0)
    v_mfma_f32_32x32x16_bf16 v[144:159], v[192:195], v[4:7], v[128:143]
    ds_read_b128 v[196:199], v8 offset:30720
    v_exp_f32 v161, v161
    v_exp_f32 v162, v162
    v_exp_f32 v163, v163
    v_exp_f32 v164, v164
    v_mfma_f32_32x32x16_bf16 v[176:191], v[204:207], v[220:223], v[176:191]
    v_exp_f32 v165, v165
    s_mov_b64 exec, s[50:51]
    ds_read_b128 v[200:203], v9 offset:28672
    ds_read_b128 v[204:207], v9 offset:29184
    s_mov_b64 exec, -1
    s_add_u32 m0, s42, 0
    s_add_u32 s44, s72, 0
    buffer_load_dwordx4 v10, s[20:23], s44 offen lds
    s_add_u32 s44, s44, 7168
    buffer_load_dwordx4 v10, s[20:23], s44 offen offset:1024 lds
    v_exp_f32 v166, v166
    v_exp_f32 v167, v167
    v_exp_f32 v168, v168
    v_cvt_pk_bf16_f32 v216, v160, v161
    v_cvt_pk_bf16_f32 v217, v162, v163
    v_cvt_pk_bf16_f32 v218, v164, v165
    v_cvt_pk_bf16_f32 v219, v166, v167
    v_exp_f32 v169, v169
    v_exp_f32 v170, v170
    v_mfma_f32_32x32x16_bf16 v[176:191], v[208:211], v[216:219], v[176:191]
    v_exp_f32 v171, v171
    v_exp_f32 v172, v172
    v_exp_f32 v173, v173
    v_exp_f32 v174, v174
    v_exp_f32_e64 v175, v175
    v_cvt_pk_bf16_f32 v220, v168, v169
    v_cvt_pk_bf16_f32 v221, v170, v171
    v_cvt_pk_bf16_f32 v222, v172, v173
    v_cvt_pk_bf16_f32 v223, v174, v175
    v_exp_f32_e64 v144, v144
    s_waitcnt lgkmcnt(0)
    s_waitcnt vmcnt(3)
    s_barrier
    s_setprio 3
    v_mfma_f32_32x32x16_bf16 v[160:175], v[196:199], v[4:7], v[128:143]
    ds_read_b128 v[192:195], v8 offset:32768
    v_exp_f32 v145, v145
    v_exp_f32 v146, v146
    v_exp_f32 v147, v147
    v_exp_f32 v148, v148
    v_mfma_f32_32x32x16_bf16 v[176:191], v[212:215], v[220:223], v[176:191]
    v_exp_f32 v149, v149
    s_mov_b64 exec, s[50:51]
    ds_read_b128 v[208:211], v9 offset:30720
    ds_read_b128 v[212:215], v9 offset:31232
    s_mov_b64 exec, -1
    s_add_u32 m0, s42, 2048
    s_add_u32 s44, s72, 16384
    buffer_load_dwordx4 v10, s[20:23], s44 offen lds
    s_add_u32 s44, s44, 7168
    buffer_load_dwordx4 v10, s[20:23], s44 offen offset:1024 lds
    v_exp_f32 v150, v150
    v_exp_f32 v151, v151
    v_exp_f32 v152, v152
    v_cvt_pk_bf16_f32 v216, v144, v145
    v_cvt_pk_bf16_f32 v217, v146, v147
    v_cvt_pk_bf16_f32 v218, v148, v149
    v_cvt_pk_bf16_f32 v219, v150, v151
    v_exp_f32 v153, v153
    v_exp_f32 v154, v154
    v_mfma_f32_32x32x16_bf16 v[176:191], v[200:203], v[216:219], v[176:191]
    v_exp_f32 v155, v155
    v_exp_f32 v156, v156
    v_exp_f32 v157, v157
    v_exp_f32 v158, v158
    v_exp_f32_e64 v159, v159
    v_cvt_pk_bf16_f32 v220, v152, v153
    v_cvt_pk_bf16_f32 v221, v154, v155
    v_cvt_pk_bf16_f32 v222, v156, v157
    v_cvt_pk_bf16_f32 v223, v158, v159
    v_exp_f32 v160, v160
    s_waitcnt lgkmcnt(0)
    v_mfma_f32_32x32x16_bf16 v[144:159], v[192:195], v[4:7], v[128:143]
    ds_read_b128 v[196:199], v8 offset:34816
    v_exp_f32 v161, v161
    v_exp_f32 v162, v162
    v_exp_f32 v163, v163
    v_exp_f32 v164, v164
    v_mfma_f32_32x32x16_bf16 v[176:191], v[204:207], v[220:223], v[176:191]
    v_exp_f32 v165, v165
    s_mov_b64 exec, s[50:51]
    ds_read_b128 v[200:203], v9 offset:32768
    ds_read_b128 v[204:207], v9 offset:33280
    s_mov_b64 exec, -1
    s_waitcnt vmcnt(4)
    s_mov_b32 s58, 0x40000
Lchk_17:
    v_cmp_eq_u64 vcc, s[54:55], v[26:27]
    s_cmp_eq_u64 vcc, exec
    s_cbranch_scc0 Lrt_18
Lok_19:
    buffer_load_dwordx4 v[224:227], v3, s[16:19], s70 offen offset:0 sc1
    buffer_load_dwordx4 v[228:231], v3, s[16:19], s71 offen offset:0 sc1
    v_exp_f32 v166, v166
    v_exp_f32 v167, v167
    v_exp_f32 v168, v168
    v_cvt_pk_bf16_f32 v216, v160, v161
    v_cvt_pk_bf16_f32 v217, v162, v163
    v_cvt_pk_bf16_f32 v218, v164, v165
    v_cvt_pk_bf16_f32 v219, v166, v167
    v_exp_f32 v169, v169
    v_exp_f32 v170, v170
    v_mfma_f32_32x32x16_bf16 v[176:191], v[208:211], v[216:219], v[176:191]
    v_exp_f32 v171, v171
    v_exp_f32 v172, v172
    v_exp_f32 v173, v173
    v_exp_f32 v174, v174
    v_exp_f32_e64 v175, v175
    v_cvt_pk_bf16_f32 v220, v168, v169
    v_cvt_pk_bf16_f32 v221, v170, v171
    v_cvt_pk_bf16_f32 v222, v172, v173
    v_cvt_pk_bf16_f32 v223, v174, v175
    v_exp_f32 v144, v144
    s_waitcnt lgkmcnt(0)
    v_mfma_f32_32x32x16_bf16 v[160:175], v[196:199], v[4:7], v[128:143]
    ds_read_b128 v[192:195], v8 offset:36864
    v_exp_f32 v145, v145
    v_exp_f32 v146, v146
    v_exp_f32 v147, v147
    v_exp_f32 v148, v148
    v_mfma_f32_32x32x16_bf16 v[176:191], v[212:215], v[220:223], v[176:191]
    v_exp_f32 v149, v149
    s_mov_b64 exec, s[50:51]
    ds_read_b128 v[208:211], v9 offset:34816
    ds_read_b128 v[212:215], v9 offset:35328
    s_mov_b64 exec, -1
    buffer_load_dwordx4 v[232:235], v3, s[16:19], s70 offen offset:1024 sc1
    buffer_load_dwordx4 v[236:239], v3, s[16:19], s71 offen offset:1024 sc1
    v_exp_f32 v150, v150
    v_exp_f32 v151, v151
    v_exp_f32 v152, v152
    v_cvt_pk_bf16_f32 v216, v144, v145
    v_cvt_pk_bf16_f32 v217, v146, v147
    v_cvt_pk_bf16_f32 v218, v148, v149
    v_cvt_pk_bf16_f32 v219, v150, v151
    v_exp_f32 v153, v153
    v_exp_f32 v154, v154
    v_mfma_f32_32x32x16_bf16 v[176:191], v[200:203], v[216:219], v[176:191]
    v_exp_f32 v155, v155
    v_exp_f32 v156, v156
    v_exp_f32 v157, v157
    v_exp_f32 v158, v158
    v_exp_f32_e64 v159, v159
    v_cvt_pk_bf16_f32 v220, v152, v153
    v_cvt_pk_bf16_f32 v221, v154, v155
    v_cvt_pk_bf16_f32 v222, v156, v157
    v_cvt_pk_bf16_f32 v223, v158, v159
    v_exp_f32 v160, v160
    s_waitcnt lgkmcnt(0)
    v_mfma_f32_32x32x16_bf16 v[144:159], v[192:195], v[4:7], v[128:143]
    ds_read_b128 v[196:199], v8 offset:38912
    v_exp_f32 v161, v161
    v_exp_f32 v162, v162
    v_exp_f32 v163, v163
    v_exp_f32 v164, v164
    v_mfma_f32_32x32x16_bf16 v[176:191], v[204:207], v[220:223], v[176:191]
    v_exp_f32 v165, v165
    s_mov_b64 exec, s[50:51]
    ds_read_b128 v[200:203], v9 offset:36864
    ds_read_b128 v[204:207], v9 offset:37376
    s_mov_b64 exec, -1
    s_lshl_b32 s83, s47, 12
    s_lshl_b32 s45, s46, 7
    s_add_u32 s83, s83, s45
    s_add_u32 s83, s83, 16515072
    v_mov_b32 v18, s54
    v_mov_b32 v19, s55
    v_mov_b32 v20, 0
    s_mov_b64 exec, 1
    buffer_store_dwordx2 v[18:19], v20, s[16:19], s83 offen sc1
    s_mov_b64 exec, -1
    v_exp_f32 v166, v166
    v_exp_f32 v167, v167
    v_exp_f32 v168, v168
    v_cvt_pk_bf16_f32 v216, v160, v161
    v_cvt_pk_bf16_f32 v217, v162, v163
    v_cvt_pk_bf16_f32 v218, v164, v165
    v_cvt_pk_bf16_f32 v219, v166, v167
    v_exp_f32 v169, v169
    v_exp_f32 v170, v170
    v_mfma_f32_32x32x16_bf16 v[176:191], v[208:211], v[216:219], v[176:191]
    v_exp_f32 v171, v171
    v_exp_f32 v172, v172
    v_exp_f32 v173, v173
    v_exp_f32 v174, v174
    v_exp_f32_e64 v175, v175
    v_cvt_pk_bf16_f32 v220, v168, v169
    v_cvt_pk_bf16_f32 v221, v170, v171
    v_cvt_pk_bf16_f32 v222, v172, v173
    v_cvt_pk_bf16_f32 v223, v174, v175
    v_exp_f32 v144, v144
    s_waitcnt lgkmcnt(0)
    v_mfma_f32_32x32x16_bf16 v[160:175], v[196:199], v[4:7], v[128:143]
    ds_read_b128 v[192:195], v8 offset:40960
    v_exp_f32 v145, v145
    v_exp_f32 v146, v146
    v_exp_f32 v147, v147
    v_exp_f32 v148, v148
    v_mfma_f32_32x32x16_bf16 v[176:191], v[212:215], v[220:223], v[176:191]
    v_exp_f32 v149, v149
    s_mov_b64 exec, s[50:51]
    ds_read_b128 v[208:211], v9 offset:38912
    ds_read_b128 v[212:215], v9 offset:39424
    s_mov_b64 exec, -1
    s_waitcnt vmcnt(7)
    ds_read_b64_tr_b16 v[240:241], v11 offset:0
    ds_read_b64_tr_b16 v[242:243], v11 offset:1024
    ds_read_b64_tr_b16 v[244:245], v15 offset:0
    ds_read_b64_tr_b16 v[246:247], v15 offset:1024
    v_exp_f32 v150, v150
    v_exp_f32 v151, v151
    v_exp_f32_e64 v152, v152
    v_cvt_pk_bf16_f32 v216, v144, v145
    v_cvt_pk_bf16_f32 v217, v146, v147
    v_cvt_pk_bf16_f32 v218, v148, v149
    v_cvt_pk_bf16_f32 v219, v150, v151
    v_exp_f32 v153, v153
    v_exp_f32 v154, v154
    v_mfma_f32_32x32x16_bf16 v[176:191], v[200:203], v[216:219], v[176:191]
    v_exp_f32 v155, v155
    v_exp_f32 v156, v156
    v_exp_f32 v157, v157
    v_exp_f32 v158, v158
    v_exp_f32_e64 v159, v159
    v_cvt_pk_bf16_f32 v220, v152, v153
    v_cvt_pk_bf16_f32 v221, v154, v155
    v_cvt_pk_bf16_f32 v222, v156, v157
    v_cvt_pk_bf16_f32 v223, v158, v159
    v_exp_f32_e64 v160, v160
    s_waitcnt lgkmcnt(0)
    s_add_u32 m0, s42, 0
    s_add_u32 s44, s72, 32768
    buffer_load_dwordx4 v10, s[20:23], s44 offen lds
    s_add_u32 s44, s44, 7168
    buffer_load_dwordx4 v10, s[20:23], s44 offen offset:1024 lds
    v_mfma_f32_32x32x16_bf16 v[144:159], v[192:195], v[4:7], v[128:143]
    ds_read_b128 v[196:199], v8 offset:43008
    v_exp_f32 v161, v161
    v_exp_f32 v162, v162
    v_exp_f32 v163, v163
    v_exp_f32 v164, v164
    v_mfma_f32_32x32x16_bf16 v[176:191], v[204:207], v[220:223], v[176:191]
    v_exp_f32 v165, v165
    s_mov_b64 exec, s[50:51]
    ds_read_b128 v[200:203], v9 offset:40960
    ds_read_b128 v[204:207], v9 offset:41472
    s_mov_b64 exec, -1
    v_exp_f32 v166, v166
    v_exp_f32 v167, v167
    s_waitcnt vmcnt(6)
    v_mfma_f32_32x32x16_bf16 v[64:79], v[240:243], v[224:227], 0
    v_exp_f32_e64 v168, v168
    v_cvt_pk_bf16_f32 v216, v160, v161
    v_cvt_pk_bf16_f32 v217, v162, v163
    v_cvt_pk_bf16_f32 v218, v164, v165
    v_cvt_pk_bf16_f32 v219, v166, v167
    v_exp_f32 v169, v169
    v_exp_f32 v170, v170
    v_mfma_f32_32x32x16_bf16 v[176:191], v[208:211], v[216:219], v[176:191]
    v_exp_f32 v171, v171
    v_exp_f32 v172, v172
    v_exp_f32_e64 v173, v173
    v_mfma_f32_32x32x16_bf16 v[80:95], v[244:247], v[224:227], 0
    v_exp_f32 v174, v174
    v_exp_f32 v175, v175
    buffer_load_dwordx4 v[224:227], v3, s[16:19], s70 offen offset:2048 sc1
    v_cvt_pk_bf16_f32 v220, v168, v169
    v_cvt_pk_bf16_f32 v221, v170, v171
    v_cvt_pk_bf16_f32 v222, v172, v173
    v_cvt_pk_bf16_f32 v223, v174, v175
    v_exp_f32 v144, v144
    s_waitcnt lgkmcnt(0)
    v_mfma_f32_32x32x16_bf16 v[160:175], v[196:199], v[4:7], v[128:143]
    ds_read_b128 v[192:195], v8 offset:45056
    v_exp_f32 v145, v145
    v_exp_f32 v146, v146
    v_exp_f32 v147, v147
    v_exp_f32 v148, v148
    v_mfma_f32_32x32x16_bf16 v[176:191], v[212:215], v[220:223], v[176:191]
    v_exp_f32 v149, v149
    s_mov_b64 exec, s[50:51]
    ds_read_b128 v[208:211], v9 offset:43008
    ds_read_b128 v[212:215], v9 offset:43520
    s_mov_b64 exec, -1
    v_exp_f32 v150, v150
    v_exp_f32 v151, v151
    v_exp_f32 v152, v152
    v_cvt_pk_bf16_f32 v216, v144, v145
    v_cvt_pk_bf16_f32 v217, v146, v147
    v_cvt_pk_bf16_f32 v218, v148, v149
    v_cvt_pk_bf16_f32 v219, v150, v151
    v_exp_f32 v153, v153
    v_exp_f32 v154, v154
    v_mfma_f32_32x32x16_bf16 v[176:191], v[200:203], v[216:219], v[176:191]
    v_exp_f32 v155, v155
    v_exp_f32 v156, v156
    v_exp_f32 v157, v157
    s_waitcnt vmcnt(6)
    v_mfma_f32_32x32x16_bf16 v[96:111], v[240:243], v[228:231], 0
    v_exp_f32 v158, v158
    v_exp_f32 v159, v159
    v_cvt_pk_bf16_f32 v220, v152, v153
    v_cvt_pk_bf16_f32 v221, v154, v155
    v_cvt_pk_bf16_f32 v222, v156, v157
    v_cvt_pk_bf16_f32 v223, v158, v159
    v_exp_f32 v160, v160
    s_waitcnt lgkmcnt(0)
    v_mfma_f32_32x32x16_bf16 v[144:159], v[192:195], v[4:7], v[128:143]
    ds_read_b128 v[196:199], v8 offset:47104
    v_exp_f32 v161, v161
    v_exp_f32 v162, v162
    v_exp_f32 v163, v163
    v_exp_f32 v164, v164
    v_mfma_f32_32x32x16_bf16 v[176:191], v[204:207], v[220:223], v[176:191]
    v_exp_f32 v165, v165
    s_mov_b64 exec, s[50:51]
    ds_read_b128 v[200:203], v9 offset:45056
    ds_read_b128 v[204:207], v9 offset:45568
    s_mov_b64 exec, -1
    ds_read_b64_tr_b16 v[248:249], v11 offset:2048
    ds_read_b64_tr_b16 v[250:251], v11 offset:3072
    ds_read_b64_tr_b16 v[252:253], v15 offset:2048
    ds_read_b64_tr_b16 v[254:255], v15 offset:3072
    v_exp_f32 v166, v166
    v_exp_f32_e64 v167, v167
    v_mfma_f32_32x32x16_bf16 v[112:127], v[244:247], v[228:231], 0
    v_exp_f32_e64 v168, v168
    v_cvt_pk_bf16_f32 v216, v160, v161
    v_cvt_pk_bf16_f32 v217, v162, v163
    v_cvt_pk_bf16_f32 v218, v164, v165
    v_cvt_pk_bf16_f32 v219, v166, v167
    v_exp_f32 v169, v169
    v_exp_f32 v170, v170
    v_mfma_f32_32x32x16_bf16 v[176:191], v[208:211], v[216:219], v[176:191]
    v_exp_f32 v171, v171
    v_exp_f32 v172, v172
    v_exp_f32 v173, v173
    v_exp_f32 v174, v174
    v_exp_f32_e64 v175, v175
    buffer_load_dwordx4 v[228:231], v3, s[16:19], s71 offen offset:2048 sc1
    v_cvt_pk_bf16_f32 v220, v168, v169
    v_cvt_pk_bf16_f32 v221, v170, v171
    v_cvt_pk_bf16_f32 v222, v172, v173
    v_cvt_pk_bf16_f32 v223, v174, v175
    v_exp_f32 v144, v144
    s_waitcnt lgkmcnt(0)
    s_add_u32 m0, s42, 2048
    s_add_u32 s44, s72, 49152
    buffer_load_dwordx4 v10, s[20:23], s44 offen lds
    s_add_u32 s44, s44, 7168
    buffer_load_dwordx4 v10, s[20:23], s44 offen offset:1024 lds
    v_mfma_f32_32x32x16_bf16 v[160:175], v[196:199], v[4:7], v[128:143]
    ds_read_b128 v[192:195], v8 offset:49152
    v_exp_f32 v145, v145
    v_exp_f32 v146, v146
    v_exp_f32 v147, v147
    v_exp_f32 v148, v148
    v_mfma_f32_32x32x16_bf16 v[176:191], v[212:215], v[220:223], v[176:191]
    v_exp_f32 v149, v149
    s_mov_b64 exec, s[50:51]
    ds_read_b128 v[208:211], v9 offset:47104
    ds_read_b128 v[212:215], v9 offset:47616
    s_mov_b64 exec, -1
    v_exp_f32 v150, v150
    v_exp_f32 v151, v151
    s_waitcnt vmcnt(8)
    v_mfma_f32_32x32x16_bf16 v[64:79], v[248:251], v[232:235], v[64:79]
    v_exp_f32_e64 v152, v152
    v_cvt_pk_bf16_f32 v216, v144, v145
    v_cvt_pk_bf16_f32 v217, v146, v147
    v_cvt_pk_bf16_f32 v218, v148, v149
    v_cvt_pk_bf16_f32 v219, v150, v151
    v_exp_f32 v153, v153
    v_exp_f32 v154, v154
    v_mfma_f32_32x32x16_bf16 v[176:191], v[200:203], v[216:219], v[176:191]
    v_exp_f32 v155, v155
    v_exp_f32 v156, v156
    v_exp_f32_e64 v157, v157
    v_mfma_f32_32x32x16_bf16 v[80:95], v[252:255], v[232:235], v[80:95]
    v_exp_f32 v158, v158
    v_exp_f32 v159, v159
    buffer_load_dwordx4 v[232:235], v3, s[16:19], s70 offen offset:3072 sc1
    s_add_u32 s70, s70, 4096
    v_cvt_pk_bf16_f32 v220, v152, v153
    v_cvt_pk_bf16_f32 v221, v154, v155
    v_cvt_pk_bf16_f32 v222, v156, v157
    v_cvt_pk_bf16_f32 v223, v158, v159
    v_exp_f32 v160, v160
    s_waitcnt lgkmcnt(0)
    v_mfma_f32_32x32x16_bf16 v[144:159], v[192:195], v[4:7], v[128:143]
    ds_read_b128 v[196:199], v8 offset:51200
    v_exp_f32 v161, v161
    v_exp_f32 v162, v162
    v_exp_f32 v163, v163
    v_exp_f32 v164, v164
    v_mfma_f32_32x32x16_bf16 v[176:191], v[204:207], v[220:223], v[176:191]
    v_exp_f32 v165, v165
    s_mov_b64 exec, s[50:51]
    ds_read_b128 v[200:203], v9 offset:49152
    ds_read_b128 v[204:207], v9 offset:49664
    s_mov_b64 exec, -1
    v_exp_f32 v166, v166
    v_exp_f32 v167, v167
    v_exp_f32 v168, v168
    v_cvt_pk_bf16_f32 v216, v160, v161
    v_cvt_pk_bf16_f32 v217, v162, v163
    v_cvt_pk_bf16_f32 v218, v164, v165
    v_cvt_pk_bf16_f32 v219, v166, v167
    v_exp_f32 v169, v169
    v_exp_f32 v170, v170
    v_mfma_f32_32x32x16_bf16 v[176:191], v[208:211], v[216:219], v[176:191]
    v_exp_f32 v171, v171
    v_exp_f32 v172, v172
    v_exp_f32 v173, v173
    s_waitcnt vmcnt(8)
    v_mfma_f32_32x32x16_bf16 v[96:111], v[248:251], v[236:239], v[96:111]
    v_exp_f32 v174, v174
    v_exp_f32 v175, v175
    v_cvt_pk_bf16_f32 v220, v168, v169
    v_cvt_pk_bf16_f32 v221, v170, v171
    v_cvt_pk_bf16_f32 v222, v172, v173
    v_cvt_pk_bf16_f32 v223, v174, v175
    v_add_u32 v8, 49152, v8
    v_add_u32 v9, 49152, v9
    v_exp_f32 v144, v144
    s_waitcnt lgkmcnt(0)
    v_mfma_f32_32x32x16_bf16 v[160:175], v[196:199], v[4:7], v[128:143]
    ds_read_b128 v[192:195], v8 offset:4096
    v_exp_f32 v145, v145
    v_exp_f32 v146, v146
    v_exp_f32 v147, v147
    v_exp_f32 v148, v148
    v_mfma_f32_32x32x16_bf16 v[176:191], v[212:215], v[220:223], v[176:191]
    v_exp_f32 v149, v149
    s_mov_b64 exec, s[50:51]
    ds_read_b128 v[208:211], v9 offset:2048
    ds_read_b128 v[212:215], v9 offset:2560
    s_mov_b64 exec, -1
    s_waitcnt vmcnt(5)
    ds_read_b64_tr_b16 v[240:241], v11 offset:0
    ds_read_b64_tr_b16 v[242:243], v11 offset:1024
    ds_read_b64_tr_b16 v[244:245], v15 offset:0
    ds_read_b64_tr_b16 v[246:247], v15 offset:1024
    v_exp_f32 v150, v150
    v_exp_f32 v151, v151
    v_mfma_f32_32x32x16_bf16 v[112:127], v[252:255], v[236:239], v[112:127]
    v_exp_f32_e64 v152, v152
    v_cvt_pk_bf16_f32 v216, v144, v145
    v_cvt_pk_bf16_f32 v217, v146, v147
    v_cvt_pk_bf16_f32 v218, v148, v149
    v_cvt_pk_bf16_f32 v219, v150, v151
    v_exp_f32 v153, v153
    v_exp_f32 v154, v154
    v_mfma_f32_32x32x16_bf16 v[176:191], v[200:203], v[216:219], v[176:191]
    v_exp_f32 v155, v155
    v_exp_f32 v156, v156
    v_exp_f32 v157, v157
    v_exp_f32 v158, v158
    v_exp_f32_e64 v159, v159
    buffer_load_dwordx4 v[236:239], v3, s[16:19], s71 offen offset:3072 sc1
    s_add_u32 s71, s71, 4096
    v_cvt_pk_bf16_f32 v220, v152, v153
    v_cvt_pk_bf16_f32 v221, v154, v155
    v_cvt_pk_bf16_f32 v222, v156, v157
    v_cvt_pk_bf16_f32 v223, v158, v159
    v_exp_f32_e64 v160, v160
    s_waitcnt lgkmcnt(0)
    s_add_u32 m0, s42, 0
    s_add_u32 s44, s72, 65536
    buffer_load_dwordx4 v10, s[20:23], s44 offen lds
    s_add_u32 s44, s44, 7168
    buffer_load_dwordx4 v10, s[20:23], s44 offen offset:1024 lds
    v_mfma_f32_32x32x16_bf16 v[144:159], v[192:195], v[4:7], v[128:143]
    ds_read_b128 v[196:199], v8 offset:6144
    v_exp_f32 v161, v161
    v_exp_f32 v162, v162
    v_exp_f32 v163, v163
    v_exp_f32 v164, v164
    v_mfma_f32_32x32x16_bf16 v[176:191], v[204:207], v[220:223], v[176:191]
    v_exp_f32 v165, v165
    s_mov_b64 exec, s[50:51]
    ds_read_b128 v[200:203], v9 offset:4096
    ds_read_b128 v[204:207], v9 offset:4608
    s_mov_b64 exec, -1
    v_exp_f32 v166, v166
    v_exp_f32 v167, v167
    s_waitcnt vmcnt(7)
    v_mfma_f32_32x32x16_bf16 v[64:79], v[240:243], v[224:227], v[64:79]
    v_exp_f32_e64 v168, v168
    v_cvt_pk_bf16_f32 v216, v160, v161
    v_cvt_pk_bf16_f32 v217, v162, v163
    v_cvt_pk_bf16_f32 v218, v164, v165
    v_cvt_pk_bf16_f32 v219, v166, v167
    v_exp_f32 v169, v169
    v_exp_f32 v170, v170
    v_mfma_f32_32x32x16_bf16 v[176:191], v[208:211], v[216:219], v[176:191]
    v_exp_f32 v171, v171
    v_exp_f32 v172, v172
    v_exp_f32_e64 v173, v173
    v_mfma_f32_32x32x16_bf16 v[80:95], v[244:247], v[224:227], v[80:95]
    v_exp_f32 v174, v174
    v_exp_f32 v175, v175
    buffer_load_dwordx4 v[224:227], v3, s[16:19], s70 offen offset:0 sc1
    v_cvt_pk_bf16_f32 v220, v168, v169
    v_cvt_pk_bf16_f32 v221, v170, v171
    v_cvt_pk_bf16_f32 v222, v172, v173
    v_cvt_pk_bf16_f32 v223, v174, v175
    v_exp_f32 v144, v144
    s_waitcnt lgkmcnt(0)
    v_mfma_f32_32x32x16_bf16 v[160:175], v[196:199], v[4:7], v[128:143]
    ds_read_b128 v[192:195], v8 offset:8192
    v_exp_f32 v145, v145
    v_exp_f32 v146, v146
    v_exp_f32 v147, v147
    v_exp_f32 v148, v148
    v_mfma_f32_32x32x16_bf16 v[176:191], v[212:215], v[220:223], v[176:191]
    v_exp_f32 v149, v149
    s_mov_b64 exec, s[50:51]
    ds_read_b128 v[208:211], v9 offset:6144
    ds_read_b128 v[212:215], v9 offset:6656
    s_mov_b64 exec, -1
    v_exp_f32 v150, v150
    v_exp_f32 v151, v151
    v_exp_f32 v152, v152
    v_cvt_pk_bf16_f32 v216, v144, v145
    v_cvt_pk_bf16_f32 v217, v146, v147
    v_cvt_pk_bf16_f32 v218, v148, v149
    v_cvt_pk_bf16_f32 v219, v150, v151
    v_exp_f32 v153, v153
    v_exp_f32 v154, v154
    v_mfma_f32_32x32x16_bf16 v[176:191], v[200:203], v[216:219], v[176:191]
    v_exp_f32 v155, v155
    v_exp_f32 v156, v156
    v_exp_f32 v157, v157
    s_waitcnt vmcnt(7)
    v_mfma_f32_32x32x16_bf16 v[96:111], v[240:243], v[228:231], v[96:111]
    v_exp_f32 v158, v158
    v_exp_f32 v159, v159
    v_cvt_pk_bf16_f32 v220, v152, v153
    v_cvt_pk_bf16_f32 v221, v154, v155
    v_cvt_pk_bf16_f32 v222, v156, v157
    v_cvt_pk_bf16_f32 v223, v158, v159
    v_exp_f32 v160, v160
    s_waitcnt lgkmcnt(0)
    v_mfma_f32_32x32x16_bf16 v[144:159], v[192:195], v[4:7], v[128:143]
    ds_read_b128 v[196:199], v8 offset:10240
    v_exp_f32 v161, v161
    v_exp_f32 v162, v162
    v_exp_f32 v163, v163
    v_exp_f32 v164, v164
    v_mfma_f32_32x32x16_bf16 v[176:191], v[204:207], v[220:223], v[176:191]
    v_exp_f32 v165, v165
    s_mov_b64 exec, s[50:51]
    ds_read_b128 v[200:203], v9 offset:8192
    ds_read_b128 v[204:207], v9 offset:8704
    s_mov_b64 exec, -1
    s_waitcnt vmcnt(5)
    ds_read_b64_tr_b16 v[248:249], v11 offset:2048
    ds_read_b64_tr_b16 v[250:251], v11 offset:3072
    ds_read_b64_tr_b16 v[252:253], v15 offset:2048
    ds_read_b64_tr_b16 v[254:255], v15 offset:3072
    v_exp_f32 v166, v166
    v_exp_f32 v167, v167
    v_mfma_f32_32x32x16_bf16 v[112:127], v[244:247], v[228:231], v[112:127]
    v_exp_f32_e64 v168, v168
    v_cvt_pk_bf16_f32 v216, v160, v161
    v_cvt_pk_bf16_f32 v217, v162, v163
    v_cvt_pk_bf16_f32 v218, v164, v165
    v_cvt_pk_bf16_f32 v219, v166, v167
    v_exp_f32 v169, v169
    v_exp_f32 v170, v170
    v_mfma_f32_32x32x16_bf16 v[176:191], v[208:211], v[216:219], v[176:191]
    v_exp_f32 v171, v171
    v_exp_f32 v172, v172
    v_exp_f32 v173, v173
    v_exp_f32 v174, v174
    v_exp_f32_e64 v175, v175
    buffer_load_dwordx4 v[228:231], v3, s[16:19], s71 offen offset:0 sc1
    v_cvt_pk_bf16_f32 v220, v168, v169
    v_cvt_pk_bf16_f32 v221, v170, v171
    v_cvt_pk_bf16_f32 v222, v172, v173
    v_cvt_pk_bf16_f32 v223, v174, v175
    v_exp_f32 v144, v144
    s_waitcnt lgkmcnt(0)
    s_add_u32 m0, s42, 2048
    s_add_u32 s44, s72, 81920
    buffer_load_dwordx4 v10, s[20:23], s44 offen lds
    s_add_u32 s44, s44, 7168
    buffer_load_dwordx4 v10, s[20:23], s44 offen offset:1024 lds
    v_mfma_f32_32x32x16_bf16 v[160:175], v[196:199], v[4:7], v[128:143]
    ds_read_b128 v[192:195], v8 offset:12288
    v_exp_f32 v145, v145
    v_exp_f32 v146, v146
    v_exp_f32 v147, v147
    v_exp_f32 v148, v148
    v_mfma_f32_32x32x16_bf16 v[176:191], v[212:215], v[220:223], v[176:191]
    v_exp_f32 v149, v149
    s_mov_b64 exec, s[50:51]
    ds_read_b128 v[208:211], v9 offset:10240
    ds_read_b128 v[212:215], v9 offset:10752
    s_mov_b64 exec, -1
    v_exp_f32 v150, v150
    v_exp_f32 v151, v151
    s_waitcnt vmcnt(7)
    v_mfma_f32_32x32x16_bf16 v[64:79], v[248:251], v[232:235], v[64:79]
    v_exp_f32_e64 v152, v152
    v_cvt_pk_bf16_f32 v216, v144, v145
    v_cvt_pk_bf16_f32 v217, v146, v147
    v_cvt_pk_bf16_f32 v218, v148, v149
    v_cvt_pk_bf16_f32 v219, v150, v151
    v_exp_f32 v153, v153
    v_exp_f32 v154, v154
    v_mfma_f32_32x32x16_bf16 v[176:191], v[200:203], v[216:219], v[176:191]
    v_exp_f32 v155, v155
    v_exp_f32 v156, v156
    v_exp_f32_e64 v157, v157
    v_mfma_f32_32x32x16_bf16 v[80:95], v[252:255], v[232:235], v[80:95]
    v_exp_f32 v158, v158
    v_exp_f32 v159, v159
    buffer_load_dwordx4 v[232:235], v3, s[16:19], s70 offen offset:1024 sc1
    v_cvt_pk_bf16_f32 v220, v152, v153
    v_cvt_pk_bf16_f32 v221, v154, v155
    v_cvt_pk_bf16_f32 v222, v156, v157
    v_cvt_pk_bf16_f32 v223, v158, v159
    v_exp_f32 v160, v160
    s_waitcnt lgkmcnt(0)
    v_mfma_f32_32x32x16_bf16 v[144:159], v[192:195], v[4:7], v[128:143]
    ds_read_b128 v[196:199], v8 offset:14336
    v_exp_f32 v161, v161
    v_exp_f32 v162, v162
    v_exp_f32 v163, v163
    v_exp_f32 v164, v164
    v_mfma_f32_32x32x16_bf16 v[176:191], v[204:207], v[220:223], v[176:191]
    v_exp_f32 v165, v165
    s_mov_b64 exec, s[50:51]
    ds_read_b128 v[200:203], v9 offset:12288
    ds_read_b128 v[204:207], v9 offset:12800
    s_mov_b64 exec, -1
    v_exp_f32 v166, v166
    v_exp_f32 v167, v167
    v_exp_f32 v168, v168
    v_cvt_pk_bf16_f32 v216, v160, v161
    v_cvt_pk_bf16_f32 v217, v162, v163
    v_cvt_pk_bf16_f32 v218, v164, v165
    v_cvt_pk_bf16_f32 v219, v166, v167
    v_exp_f32 v169, v169
    v_exp_f32 v170, v170
    v_mfma_f32_32x32x16_bf16 v[176:191], v[208:211], v[216:219], v[176:191]
    v_exp_f32 v171, v171
    v_exp_f32 v172, v172
    v_exp_f32 v173, v173
    s_waitcnt vmcnt(7)
    v_mfma_f32_32x32x16_bf16 v[96:111], v[248:251], v[236:239], v[96:111]
    v_exp_f32 v174, v174
    v_exp_f32 v175, v175
    v_cvt_pk_bf16_f32 v220, v168, v169
    v_cvt_pk_bf16_f32 v221, v170, v171
    v_cvt_pk_bf16_f32 v222, v172, v173
    v_cvt_pk_bf16_f32 v223, v174, v175
    v_exp_f32 v144, v144
    s_waitcnt lgkmcnt(0)
    v_mfma_f32_32x32x16_bf16 v[160:175], v[196:199], v[4:7], v[128:143]
    ds_read_b128 v[192:195], v8 offset:16384
    v_exp_f32 v145, v145
    v_exp_f32 v146, v146
    v_exp_f32 v147, v147
    v_exp_f32 v148, v148
    v_mfma_f32_32x32x16_bf16 v[176:191], v[212:215], v[220:223], v[176:191]
    v_exp_f32 v149, v149
    s_mov_b64 exec, s[50:51]
    ds_read_b128 v[208:211], v9 offset:14336
    ds_read_b128 v[212:215], v9 offset:14848
    s_mov_b64 exec, -1
    s_waitcnt vmcnt(5)
    ds_read_b64_tr_b16 v[240:241], v11 offset:0
    ds_read_b64_tr_b16 v[242:243], v11 offset:1024
    ds_read_b64_tr_b16 v[244:245], v15 offset:0
    ds_read_b64_tr_b16 v[246:247], v15 offset:1024
    v_exp_f32 v150, v150
    v_exp_f32 v151, v151
    v_mfma_f32_32x32x16_bf16 v[112:127], v[252:255], v[236:239], v[112:127]
    v_exp_f32_e64 v152, v152
    v_cvt_pk_bf16_f32 v216, v144, v145
    v_cvt_pk_bf16_f32 v217, v146, v147
    v_cvt_pk_bf16_f32 v218, v148, v149
    v_cvt_pk_bf16_f32 v219, v150, v151
    v_exp_f32 v153, v153
    v_exp_f32 v154, v154
    v_mfma_f32_32x32x16_bf16 v[176:191], v[200:203], v[216:219], v[176:191]
    v_exp_f32 v155, v155
    v_exp_f32 v156, v156
    v_exp_f32 v157, v157
    v_exp_f32 v158, v158
    v_exp_f32_e64 v159, v159
    buffer_load_dwordx4 v[236:239], v3, s[16:19], s71 offen offset:1024 sc1
    v_cvt_pk_bf16_f32 v220, v152, v153
    v_cvt_pk_bf16_f32 v221, v154, v155
    v_cvt_pk_bf16_f32 v222, v156, v157
    v_cvt_pk_bf16_f32 v223, v158, v159
    v_exp_f32_e64 v160, v160
    s_waitcnt lgkmcnt(0)
    s_add_u32 m0, s42, 0
    s_add_u32 s44, s72, 98304
    buffer_load_dwordx4 v10, s[20:23], s44 offen lds
    s_add_u32 s44, s44, 7168
    buffer_load_dwordx4 v10, s[20:23], s44 offen offset:1024 lds
    v_mfma_f32_32x32x16_bf16 v[144:159], v[192:195], v[4:7], v[128:143]
    ds_read_b128 v[196:199], v8 offset:18432
    v_exp_f32 v161, v161
    v_exp_f32 v162, v162
    v_exp_f32 v163, v163
    v_exp_f32 v164, v164
    v_mfma_f32_32x32x16_bf16 v[176:191], v[204:207], v[220:223], v[176:191]
    v_exp_f32 v165, v165
    s_mov_b64 exec, s[50:51]
    ds_read_b128 v[200:203], v9 offset:16384
    ds_read_b128 v[204:207], v9 offset:16896
    s_mov_b64 exec, -1
    v_exp_f32 v166, v166
    v_exp_f32 v167, v167
    s_waitcnt vmcnt(7)
    v_mfma_f32_32x32x16_bf16 v[64:79], v[240:243], v[224:227], v[64:79]
    v_exp_f32_e64 v168, v168
    v_cvt_pk_bf16_f32 v216, v160, v161
    v_cvt_pk_bf16_f32 v217, v162, v163
    v_cvt_pk_bf16_f32 v218, v164, v165
    v_cvt_pk_bf16_f32 v219, v166, v167
    v_exp_f32 v169, v169
    v_exp_f32 v170, v170
    v_mfma_f32_32x32x16_bf16 v[176:191], v[208:211], v[216:219], v[176:191]
    v_exp_f32 v171, v171
    v_exp_f32 v172, v172
    v_exp_f32_e64 v173, v173
    v_mfma_f32_32x32x16_bf16 v[80:95], v[244:247], v[224:227], v[80:95]
    v_exp_f32 v174, v174
    v_exp_f32 v175, v175
    buffer_load_dwordx4 v[224:227], v3, s[16:19], s70 offen offset:2048 sc1
    v_cvt_pk_bf16_f32 v220, v168, v169
    v_cvt_pk_bf16_f32 v221, v170, v171
    v_cvt_pk_bf16_f32 v222, v172, v173
    v_cvt_pk_bf16_f32 v223, v174, v175
    v_exp_f32 v144, v144
    s_waitcnt lgkmcnt(0)
    v_mfma_f32_32x32x16_bf16 v[160:175], v[196:199], v[4:7], v[128:143]
    ds_read_b128 v[192:195], v8 offset:20480
    v_exp_f32 v145, v145
    v_exp_f32 v146, v146
    v_exp_f32 v147, v147
    v_exp_f32 v148, v148
    v_mfma_f32_32x32x16_bf16 v[176:191], v[212:215], v[220:223], v[176:191]
    v_exp_f32 v149, v149
    s_mov_b64 exec, s[50:51]
    ds_read_b128 v[208:211], v9 offset:18432
    ds_read_b128 v[212:215], v9 offset:18944
    s_mov_b64 exec, -1
    v_exp_f32 v150, v150
    v_exp_f32 v151, v151
    v_exp_f32 v152, v152
    v_cvt_pk_bf16_f32 v216, v144, v145
    v_cvt_pk_bf16_f32 v217, v146, v147
    v_cvt_pk_bf16_f32 v218, v148, v149
    v_cvt_pk_bf16_f32 v219, v150, v151
    v_exp_f32 v153, v153
    v_exp_f32 v154, v154
    v_mfma_f32_32x32x16_bf16 v[176:191], v[200:203], v[216:219], v[176:191]
    v_exp_f32 v155, v155
    v_exp_f32 v156, v156
    v_exp_f32 v157, v157
    s_waitcnt vmcnt(7)
    v_mfma_f32_32x32x16_bf16 v[96:111], v[240:243], v[228:231], v[96:111]
    v_exp_f32 v158, v158
    v_exp_f32 v159, v159
    v_cvt_pk_bf16_f32 v220, v152, v153
    v_cvt_pk_bf16_f32 v221, v154, v155
    v_cvt_pk_bf16_f32 v222, v156, v157
    v_cvt_pk_bf16_f32 v223, v158, v159
    v_exp_f32 v160, v160
    s_waitcnt lgkmcnt(0)
    v_mfma_f32_32x32x16_bf16 v[144:159], v[192:195], v[4:7], v[128:143]
    ds_read_b128 v[196:199], v8 offset:22528
    v_exp_f32 v161, v161
    v_exp_f32 v162, v162
    v_exp_f32 v163, v163
    v_exp_f32 v164, v164
    v_mfma_f32_32x32x16_bf16 v[176:191], v[204:207], v[220:223], v[176:191]
    v_exp_f32 v165, v165
    s_mov_b64 exec, s[50:51]
    ds_read_b128 v[200:203], v9 offset:20480
    ds_read_b128 v[204:207], v9 offset:20992
    s_mov_b64 exec, -1
    s_waitcnt vmcnt(5)
    ds_read_b64_tr_b16 v[248:249], v11 offset:2048
    ds_read_b64_tr_b16 v[250:251], v11 offset:3072
    ds_read_b64_tr_b16 v[252:253], v15 offset:2048
    ds_read_b64_tr_b16 v[254:255], v15 offset:3072
    v_exp_f32 v166, v166
    v_exp_f32 v167, v167
    v_mfma_f32_32x32x16_bf16 v[112:127], v[244:247], v[228:231], v[112:127]
    v_exp_f32_e64 v168, v168
    v_cvt_pk_bf16_f32 v216, v160, v161
    v_cvt_pk_bf16_f32 v217, v162, v163
    v_cvt_pk_bf16_f32 v218, v164, v165
    v_cvt_pk_bf16_f32 v219, v166, v167
    v_exp_f32 v169, v169
    v_exp_f32 v170, v170
    v_mfma_f32_32x32x16_bf16 v[176:191], v[208:211], v[216:219], v[176:191]
    v_exp_f32 v171, v171
    v_exp_f32 v172, v172
    v_exp_f32 v173, v173
    v_exp_f32 v174, v174
    v_exp_f32_e64 v175, v175
    buffer_load_dwordx4 v[228:231], v3, s[16:19], s71 offen offset:2048 sc1
    v_cvt_pk_bf16_f32 v220, v168, v169
    v_cvt_pk_bf16_f32 v221, v170, v171
    v_cvt_pk_bf16_f32 v222, v172, v173
    v_cvt_pk_bf16_f32 v223, v174, v175
    v_exp_f32 v144, v144
    s_waitcnt lgkmcnt(0)
    s_add_u32 m0, s42, 2048
    s_add_u32 s44, s72, 114688
    buffer_load_dwordx4 v10, s[20:23], s44 offen lds
    s_add_u32 s44, s44, 7168
    buffer_load_dwordx4 v10, s[20:23], s44 offen offset:1024 lds
    v_mfma_f32_32x32x16_bf16 v[160:175], v[196:199], v[4:7], v[128:143]
    ds_read_b128 v[192:195], v8 offset:24576
    v_exp_f32 v145, v145
    v_exp_f32 v146, v146
    v_exp_f32 v147, v147
    v_exp_f32 v148, v148
    v_mfma_f32_32x32x16_bf16 v[176:191], v[212:215], v[220:223], v[176:191]
    v_exp_f32 v149, v149
    s_mov_b64 exec, s[50:51]
    ds_read_b128 v[208:211], v9 offset:22528
    ds_read_b128 v[212:215], v9 offset:23040
    s_mov_b64 exec, -1
    v_exp_f32 v150, v150
    v_exp_f32 v151, v151
    s_waitcnt vmcnt(7)
    v_mfma_f32_32x32x16_bf16 v[64:79], v[248:251], v[232:235], v[64:79]
    v_exp_f32_e64 v152, v152
    v_cvt_pk_bf16_f32 v216, v144, v145
    v_cvt_pk_bf16_f32 v217, v146, v147
    v_cvt_pk_bf16_f32 v218, v148, v149
    v_cvt_pk_bf16_f32 v219, v150, v151
    v_exp_f32 v153, v153
    v_exp_f32 v154, v154
    v_mfma_f32_32x32x16_bf16 v[176:191], v[200:203], v[216:219], v[176:191]
    v_exp_f32 v155, v155
    v_exp_f32 v156, v156
    v_exp_f32_e64 v157, v157
    v_mfma_f32_32x32x16_bf16 v[80:95], v[252:255], v[232:235], v[80:95]
    v_exp_f32 v158, v158
    v_exp_f32 v159, v159
    buffer_load_dwordx4 v[232:235], v3, s[16:19], s70 offen offset:3072 sc1
    s_add_u32 s70, s70, 4096
    v_cvt_pk_bf16_f32 v220, v152, v153
    v_cvt_pk_bf16_f32 v221, v154, v155
    v_cvt_pk_bf16_f32 v222, v156, v157
    v_cvt_pk_bf16_f32 v223, v158, v159
    v_exp_f32 v160, v160
    s_waitcnt lgkmcnt(0)
    v_mfma_f32_32x32x16_bf16 v[144:159], v[192:195], v[4:7], v[128:143]
    ds_read_b128 v[196:199], v8 offset:26624
    v_exp_f32 v161, v161
    v_exp_f32 v162, v162
    v_exp_f32 v163, v163
    v_exp_f32 v164, v164
    v_mfma_f32_32x32x16_bf16 v[176:191], v[204:207], v[220:223], v[176:191]
    v_exp_f32 v165, v165
    s_mov_b64 exec, s[50:51]
    ds_read_b128 v[200:203], v9 offset:24576
    ds_read_b128 v[204:207], v9 offset:25088
    s_mov_b64 exec, -1
    v_exp_f32 v166, v166
    v_exp_f32 v167, v167
    v_exp_f32 v168, v168
    v_cvt_pk_bf16_f32 v216, v160, v161
    v_cvt_pk_bf16_f32 v217, v162, v163
    v_cvt_pk_bf16_f32 v218, v164, v165
    v_cvt_pk_bf16_f32 v219, v166, v167
    v_exp_f32 v169, v169
    v_exp_f32 v170, v170
    v_mfma_f32_32x32x16_bf16 v[176:191], v[208:211], v[216:219], v[176:191]
    v_exp_f32 v171, v171
    v_exp_f32 v172, v172
    v_exp_f32 v173, v173
    s_waitcnt vmcnt(7)
    v_mfma_f32_32x32x16_bf16 v[96:111], v[248:251], v[236:239], v[96:111]
    v_exp_f32 v174, v174
    v_exp_f32 v175, v175
    v_cvt_pk_bf16_f32 v220, v168, v169
    v_cvt_pk_bf16_f32 v221, v170, v171
    v_cvt_pk_bf16_f32 v222, v172, v173
    v_cvt_pk_bf16_f32 v223, v174, v175
    v_exp_f32 v144, v144
    s_waitcnt lgkmcnt(0)
    v_mfma_f32_32x32x16_bf16 v[160:175], v[196:199], v[4:7], v[128:143]
    ds_read_b128 v[192:195], v8 offset:28672
    v_exp_f32 v145, v145
    v_exp_f32 v146, v146
    v_exp_f32 v147, v147
    v_exp_f32 v148, v148
    v_mfma_f32_32x32x16_bf16 v[176:191], v[212:215], v[220:223], v[176:191]
    v_exp_f32 v149, v149
    s_mov_b64 exec, s[50:51]
    ds_read_b128 v[208:211], v9 offset:26624
    ds_read_b128 v[212:215], v9 offset:27136
    s_mov_b64 exec, -1
    s_waitcnt vmcnt(5)
    ds_read_b64_tr_b16 v[240:241], v11 offset:0
    ds_read_b64_tr_b16 v[242:243], v11 offset:1024
    ds_read_b64_tr_b16 v[244:245], v15 offset:0
    ds_read_b64_tr_b16 v[246:247], v15 offset:1024
    v_exp_f32 v150, v150
    v_exp_f32 v151, v151
    v_mfma_f32_32x32x16_bf16 v[112:127], v[252:255], v[236:239], v[112:127]
    v_exp_f32_e64 v152, v152
    v_cvt_pk_bf16_f32 v216, v144, v145
    v_cvt_pk_bf16_f32 v217, v146, v147
    v_cvt_pk_bf16_f32 v218, v148, v149
    v_cvt_pk_bf16_f32 v219, v150, v151
    v_exp_f32 v153, v153
    v_exp_f32 v154, v154
    v_mfma_f32_32x32x16_bf16 v[176:191], v[200:203], v[216:219], v[176:191]
    v_exp_f32 v155, v155
    v_exp_f32 v156, v156
    v_exp_f32 v157, v157
    v_exp_f32 v158, v158
    v_exp_f32_e64 v159, v159
    buffer_load_dwordx4 v[236:239], v3, s[16:19], s71 offen offset:3072 sc1
    s_add_u32 s71, s71, 4096
    v_cvt_pk_bf16_f32 v220, v152, v153
    v_cvt_pk_bf16_f32 v221, v154, v155
    v_cvt_pk_bf16_f32 v222, v156, v157
    v_cvt_pk_bf16_f32 v223, v158, v159
    v_exp_f32_e64 v160, v160
    s_waitcnt lgkmcnt(0)
    s_add_u32 m0, s42, 0
    s_add_u32 s44, s72, 131072
    buffer_load_dwordx4 v10, s[20:23], s44 offen lds
    s_add_u32 s44, s44, 7168
    buffer_load_dwordx4 v10, s[20:23], s44 offen offset:1024 lds
    v_mfma_f32_32x32x16_bf16 v[144:159], v[192:195], v[4:7], v[128:143]
    ds_read_b128 v[196:199], v8 offset:30720
    v_exp_f32 v161, v161
    v_exp_f32 v162, v162
    v_exp_f32 v163, v163
    v_exp_f32 v164, v164
    v_mfma_f32_32x32x16_bf16 v[176:191], v[204:207], v[220:223], v[176:191]
    v_exp_f32 v165, v165
    s_mov_b64 exec, s[50:51]
    ds_read_b128 v[200:203], v9 offset:28672
    ds_read_b128 v[204:207], v9 offset:29184
    s_mov_b64 exec, -1
    v_exp_f32 v166, v166
    v_exp_f32 v167, v167
    s_waitcnt vmcnt(7)
    v_mfma_f32_32x32x16_bf16 v[64:79], v[240:243], v[224:227], v[64:79]
    v_exp_f32_e64 v168, v168
    v_cvt_pk_bf16_f32 v216, v160, v161
    v_cvt_pk_bf16_f32 v217, v162, v163
    v_cvt_pk_bf16_f32 v218, v164, v165
    v_cvt_pk_bf16_f32 v219, v166, v167
    v_exp_f32 v169, v169
    v_exp_f32 v170, v170
    v_mfma_f32_32x32x16_bf16 v[176:191], v[208:211], v[216:219], v[176:191]
    v_exp_f32 v171, v171
    v_exp_f32 v172, v172
    v_exp_f32_e64 v173, v173
    v_mfma_f32_32x32x16_bf16 v[80:95], v[244:247], v[224:227], v[80:95]
    v_exp_f32 v174, v174
    v_exp_f32 v175, v175
    buffer_load_dwordx4 v[224:227], v3, s[16:19], s70 offen offset:0 sc1
    v_cvt_pk_bf16_f32 v220, v168, v169
    v_cvt_pk_bf16_f32 v221, v170, v171
    v_cvt_pk_bf16_f32 v222, v172, v173
    v_cvt_pk_bf16_f32 v223, v174, v175
    v_exp_f32_e64 v144, v144
    s_waitcnt lgkmcnt(0)
    s_setprio 2
    v_mfma_f32_32x32x16_bf16 v[160:175], v[196:199], v[4:7], v[128:143]
    ds_read_b128 v[192:195], v8 offset:32768
    v_exp_f32 v145, v145
    v_exp_f32 v146, v146
    v_exp_f32 v147, v147
    v_exp_f32 v148, v148
    v_mfma_f32_32x32x16_bf16 v[176:191], v[212:215], v[220:223], v[176:191]
    v_exp_f32 v149, v149
    s_mov_b64 exec, s[50:51]
    ds_read_b128 v[208:211], v9 offset:30720
    ds_read_b128 v[212:215], v9 offset:31232
    s_mov_b64 exec, -1
    v_exp_f32 v150, v150
    v_exp_f32 v151, v151
    v_exp_f32 v152, v152
    v_cvt_pk_bf16_f32 v216, v144, v145
    v_cvt_pk_bf16_f32 v217, v146, v147
    v_cvt_pk_bf16_f32 v218, v148, v149
    v_cvt_pk_bf16_f32 v219, v150, v151
    v_exp_f32 v153, v153
    v_exp_f32 v154, v154
    v_mfma_f32_32x32x16_bf16 v[176:191], v[200:203], v[216:219], v[176:191]
    v_exp_f32 v155, v155
    v_exp_f32 v156, v156
    v_exp_f32 v157, v157
    s_waitcnt vmcnt(7)
    v_mfma_f32_32x32x16_bf16 v[96:111], v[240:243], v[228:231], v[96:111]
    v_exp_f32 v158, v158
    v_exp_f32 v159, v159
    v_and_b32 v21, 7, v2
    v_lshlrev_b32_e64 v21, 7, v21
    s_lshl_b32 s80, s75, 12
    s_lshl_b32 s44, s52, 10
    s_add_u32 s80, s80, s44
    s_add_u32 s80, s80, 16515072
    buffer_load_dwordx2 v[26:27], v21, s[16:19], s80 offen sc1
    v_cvt_pk_bf16_f32 v220, v152, v153
    v_cvt_pk_bf16_f32 v221, v154, v155
    v_cvt_pk_bf16_f32 v222, v156, v157
    v_cvt_pk_bf16_f32 v223, v158, v159
    v_exp_f32 v160, v160
    s_waitcnt lgkmcnt(0)
    v_mfma_f32_32x32x16_bf16 v[144:159], v[192:195], v[4:7], v[128:143]
    ds_read_b128 v[196:199], v8 offset:34816
    v_exp_f32 v161, v161
    v_exp_f32 v162, v162
    v_exp_f32 v163, v163
    v_exp_f32 v164, v164
    v_mfma_f32_32x32x16_bf16 v[176:191], v[204:207], v[220:223], v[176:191]
    v_exp_f32 v165, v165
    s_mov_b64 exec, s[50:51]
    ds_read_b128 v[200:203], v9 offset:32768
    ds_read_b128 v[204:207], v9 offset:33280
    s_mov_b64 exec, -1
    s_waitcnt vmcnt(6)
    ds_read_b64_tr_b16 v[248:249], v11 offset:2048
    ds_read_b64_tr_b16 v[250:251], v11 offset:3072
    ds_read_b64_tr_b16 v[252:253], v15 offset:2048
    ds_read_b64_tr_b16 v[254:255], v15 offset:3072
    v_exp_f32 v166, v166
    v_exp_f32 v167, v167
    v_mfma_f32_32x32x16_bf16 v[112:127], v[244:247], v[228:231], v[112:127]
    v_exp_f32_e64 v168, v168
    v_cvt_pk_bf16_f32 v216, v160, v161
    v_cvt_pk_bf16_f32 v217, v162, v163
    v_cvt_pk_bf16_f32 v218, v164, v165
    v_cvt_pk_bf16_f32 v219, v166, v167
    v_exp_f32 v169, v169
    v_exp_f32 v170, v170
    v_mfma_f32_32x32x16_bf16 v[176:191], v[208:211], v[216:219], v[176:191]
    v_exp_f32 v171, v171
    v_exp_f32 v172, v172
    v_exp_f32 v173, v173
    v_exp_f32 v174, v174
    v_exp_f32_e64 v175, v175
    buffer_load_dwordx4 v[228:231], v3, s[16:19], s71 offen offset:0 sc1
    v_cvt_pk_bf16_f32 v220, v168, v169
    v_cvt_pk_bf16_f32 v221, v170, v171
    v_cvt_pk_bf16_f32 v222, v172, v173
    v_cvt_pk_bf16_f32 v223, v174, v175
    v_exp_f32 v144, v144
    s_waitcnt lgkmcnt(0)
    s_add_u32 m0, s42, 2048
    s_add_u32 s44, s72, 147456
    buffer_load_dwordx4 v10, s[20:23], s44 offen lds
    s_add_u32 s44, s44, 7168
    buffer_load_dwordx4 v10, s[20:23], s44 offen offset:1024 lds
    v_mfma_f32_32x32x16_bf16 v[160:175], v[196:199], v[4:7], v[128:143]
    ds_read_b128 v[192:195], v8 offset:36864
    v_exp_f32 v145, v145
    v_exp_f32 v146, v146
    v_exp_f32 v147, v147
    v_exp_f32 v148, v148
    v_mfma_f32_32x32x16_bf16 v[176:191], v[212:215], v[220:223], v[176:191]
    v_exp_f32 v149, v149
    s_mov_b64 exec, s[50:51]
    ds_read_b128 v[208:211], v9 offset:34816
    ds_read_b128 v[212:215], v9 offset:35328
    s_mov_b64 exec, -1
    v_exp_f32 v150, v150
    v_exp_f32 v151, v151
    s_waitcnt vmcnt(8)
    v_mfma_f32_32x32x16_bf16 v[64:79], v[248:251], v[232:235], v[64:79]
    v_exp_f32_e64 v152, v152
    v_cvt_pk_bf16_f32 v216, v144, v145
    v_cvt_pk_bf16_f32 v217, v146, v147
    v_cvt_pk_bf16_f32 v218, v148, v149
    v_cvt_pk_bf16_f32 v219, v150, v151
    v_exp_f32 v153, v153
    v_exp_f32 v154, v154
    v_mfma_f32_32x32x16_bf16 v[176:191], v[200:203], v[216:219], v[176:191]
    v_exp_f32 v155, v155
    v_exp_f32 v156, v156
    v_exp_f32_e64 v157, v157
    v_mfma_f32_32x32x16_bf16 v[80:95], v[252:255], v[232:235], v[80:95]
    v_exp_f32 v158, v158
    v_exp_f32 v159, v159
    buffer_load_dwordx4 v[232:235], v3, s[16:19], s70 offen offset:1024 sc1
    v_cvt_pk_bf16_f32 v220, v152, v153
    v_cvt_pk_bf16_f32 v221, v154, v155
    v_cvt_pk_bf16_f32 v222, v156, v157
    v_cvt_pk_bf16_f32 v223, v158, v159
    v_exp_f32 v160, v160
    s_waitcnt lgkmcnt(0)
    v_mfma_f32_32x32x16_bf16 v[144:159], v[192:195], v[4:7], v[128:143]
    ds_read_b128 v[196:199], v8 offset:38912
    v_exp_f32 v161, v161
    v_exp_f32 v162, v162
    v_exp_f32 v163, v163
    v_exp_f32 v164, v164
    v_mfma_f32_32x32x16_bf16 v[176:191], v[204:207], v[220:223], v[176:191]
    v_exp_f32 v165, v165
    s_mov_b64 exec, s[50:51]
    ds_read_b128 v[200:203], v9 offset:36864
    ds_read_b128 v[204:207], v9 offset:37376
    s_mov_b64 exec, -1
    v_exp_f32 v166, v166
    v_exp_f32 v167, v167
    v_exp_f32 v168, v168
    v_cvt_pk_bf16_f32 v216, v160, v161
    v_cvt_pk_bf16_f32 v217, v162, v163
    v_cvt_pk_bf16_f32 v218, v164, v165
    v_cvt_pk_bf16_f32 v219, v166, v167
    v_exp_f32 v169, v169
    v_exp_f32 v170, v170
    v_mfma_f32_32x32x16_bf16 v[176:191], v[208:211], v[216:219], v[176:191]
    v_exp_f32 v171, v171
    v_exp_f32 v172, v172
    v_exp_f32 v173, v173
    s_waitcnt vmcnt(8)
    v_mfma_f32_32x32x16_bf16 v[96:111], v[248:251], v[236:239], v[96:111]
    v_exp_f32 v174, v174
    v_exp_f32 v175, v175
    v_cvt_pk_bf16_f32 v220, v168, v169
    v_cvt_pk_bf16_f32 v221, v170, v171
    v_cvt_pk_bf16_f32 v222, v172, v173
    v_cvt_pk_bf16_f32 v223, v174, v175
    v_exp_f32 v144, v144
    s_waitcnt lgkmcnt(0)
    v_mfma_f32_32x32x16_bf16 v[160:175], v[196:199], v[4:7], v[128:143]
    ds_read_b128 v[192:195], v8 offset:40960
    v_exp_f32 v145, v145
    v_exp_f32 v146, v146
    v_exp_f32 v147, v147
    v_exp_f32 v148, v148
    v_mfma_f32_32x32x16_bf16 v[176:191], v[212:215], v[220:223], v[176:191]
    v_exp_f32 v149, v149
    s_mov_b64 exec, s[50:51]
    ds_read_b128 v[208:211], v9 offset:38912
    ds_read_b128 v[212:215], v9 offset:39424
    s_mov_b64 exec, -1
    s_waitcnt vmcnt(6)
    ds_read_b64_tr_b16 v[240:241], v11 offset:0
    ds_read_b64_tr_b16 v[242:243], v11 offset:1024
    ds_read_b64_tr_b16 v[244:245], v15 offset:0
    ds_read_b64_tr_b16 v[246:247], v15 offset:1024
    v_exp_f32 v150, v150
    v_exp_f32 v151, v151
    v_mfma_f32_32x32x16_bf16 v[112:127], v[252:255], v[236:239], v[112:127]
    v_exp_f32_e64 v152, v152
    v_cvt_pk_bf16_f32 v216, v144, v145
    v_cvt_pk_bf16_f32 v217, v146, v147
    v_cvt_pk_bf16_f32 v218, v148, v149
    v_cvt_pk_bf16_f32 v219, v150, v151
    v_exp_f32 v153, v153
    v_exp_f32 v154, v154
    v_mfma_f32_32x32x16_bf16 v[176:191], v[200:203], v[216:219], v[176:191]
    v_exp_f32 v155, v155
    v_exp_f32 v156, v156
    v_exp_f32 v157, v157
    v_exp_f32 v158, v158
    v_exp_f32_e64 v159, v159
    buffer_load_dwordx4 v[236:239], v3, s[16:19], s71 offen offset:1024 sc1
    v_cvt_pk_bf16_f32 v220, v152, v153
    v_cvt_pk_bf16_f32 v221, v154, v155
    v_cvt_pk_bf16_f32 v222, v156, v157
    v_cvt_pk_bf16_f32 v223, v158, v159
    v_exp_f32_e64 v160, v160
    s_waitcnt lgkmcnt(0)
    s_add_u32 m0, s42, 0
    s_add_u32 s44, s72, 163840
    buffer_load_dwordx4 v10, s[20:23], s44 offen lds
    s_add_u32 s44, s44, 7168
    buffer_load_dwordx4 v10, s[20:23], s44 offen offset:1024 lds
    v_mfma_f32_32x32x16_bf16 v[144:159], v[192:195], v[4:7], v[128:143]
    ds_read_b128 v[196:199], v8 offset:43008
    v_exp_f32 v161, v161
    v_exp_f32 v162, v162
    v_exp_f32 v163, v163
    v_exp_f32 v164, v164
    v_mfma_f32_32x32x16_bf16 v[176:191], v[204:207], v[220:223], v[176:191]
    v_exp_f32 v165, v165
    s_mov_b64 exec, s[50:51]
    ds_read_b128 v[200:203], v9 offset:40960
    ds_read_b128 v[204:207], v9 offset:41472
    s_mov_b64 exec, -1
    v_exp_f32 v166, v166
    v_exp_f32 v167, v167
    s_waitcnt vmcnt(8)
    v_mfma_f32_32x32x16_bf16 v[64:79], v[240:243], v[224:227], v[64:79]
    v_exp_f32_e64 v168, v168
    v_cvt_pk_bf16_f32 v216, v160, v161
    v_cvt_pk_bf16_f32 v217, v162, v163
    v_cvt_pk_bf16_f32 v218, v164, v165
    v_cvt_pk_bf16_f32 v219, v166, v167
    v_exp_f32 v169, v169
    v_exp_f32 v170, v170
    v_mfma_f32_32x32x16_bf16 v[176:191], v[208:211], v[216:219], v[176:191]
    v_exp_f32 v171, v171
    v_exp_f32 v172, v172
    v_exp_f32_e64 v173, v173
    v_mfma_f32_32x32x16_bf16 v[80:95], v[244:247], v[224:227], v[80:95]
    v_exp_f32 v174, v174
    v_exp_f32 v175, v175
    buffer_load_dwordx4 v[224:227], v3, s[16:19], s70 offen offset:2048 sc1
    v_cvt_pk_bf16_f32 v220, v168, v169
    v_cvt_pk_bf16_f32 v221, v170, v171
    v_cvt_pk_bf16_f32 v222, v172, v173
    v_cvt_pk_bf16_f32 v223, v174, v175
    v_exp_f32 v144, v144
    s_waitcnt lgkmcnt(0)
    v_mfma_f32_32x32x16_bf16 v[160:175], v[196:199], v[4:7], v[128:143]
    ds_read_b128 v[192:195], v8 offset:45056
    v_exp_f32 v145, v145
    v_exp_f32 v146, v146
    v_exp_f32 v147, v147
    v_exp_f32 v148, v148
    v_mfma_f32_32x32x16_bf16 v[176:191], v[212:215], v[220:223], v[176:191]
    v_exp_f32 v149, v149
    s_mov_b64 exec, s[50:51]
    ds_read_b128 v[208:211], v9 offset:43008
    ds_read_b128 v[212:215], v9 offset:43520
    s_mov_b64 exec, -1
    v_exp_f32 v150, v150
    v_exp_f32 v151, v151
    v_exp_f32 v152, v152
    v_cvt_pk_bf16_f32 v216, v144, v145
    v_cvt_pk_bf16_f32 v217, v146, v147
    v_cvt_pk_bf16_f32 v218, v148, v149
    v_cvt_pk_bf16_f32 v219, v150, v151
    v_exp_f32 v153, v153
    v_exp_f32 v154, v154
    v_mfma_f32_32x32x16_bf16 v[176:191], v[200:203], v[216:219], v[176:191]
    v_exp_f32 v155, v155
    v_exp_f32 v156, v156
    v_exp_f32 v157, v157
    s_waitcnt vmcnt(7)
    v_mfma_f32_32x32x16_bf16 v[96:111], v[240:243], v[228:231], v[96:111]
    v_exp_f32 v158, v158
    v_exp_f32 v159, v159
    s_mov_b32 s58, 0x40000
Lchk_20:
    v_cmp_eq_u64 vcc, s[54:55], v[26:27]
    s_cmp_eq_u64 vcc, exec
    s_cbranch_scc0 Lrt_21
Lok_22:
    v_cvt_pk_bf16_f32 v220, v152, v153
    v_cvt_pk_bf16_f32 v221, v154, v155
    v_cvt_pk_bf16_f32 v222, v156, v157
    v_cvt_pk_bf16_f32 v223, v158, v159
    v_exp_f32 v160, v160
    s_waitcnt lgkmcnt(0)
    s_setprio 1
    v_mfma_f32_32x32x16_bf16 v[144:159], v[192:195], v[4:7], v[128:143]
    ds_read_b128 v[196:199], v8 offset:47104
    v_exp_f32 v161, v161
    v_exp_f32 v162, v162
    v_exp_f32 v163, v163
    v_exp_f32 v164, v164
    v_mfma_f32_32x32x16_bf16 v[176:191], v[204:207], v[220:223], v[176:191]
    v_exp_f32 v165, v165
    s_mov_b64 exec, s[50:51]
    ds_read_b128 v[200:203], v9 offset:45056
    ds_read_b128 v[204:207], v9 offset:45568
    s_mov_b64 exec, -1
    s_waitcnt vmcnt(5)
    ds_read_b64_tr_b16 v[248:249], v11 offset:2048
    ds_read_b64_tr_b16 v[250:251], v11 offset:3072
    ds_read_b64_tr_b16 v[252:253], v15 offset:2048
    ds_read_b64_tr_b16 v[254:255], v15 offset:3072
    v_exp_f32 v166, v166
    v_exp_f32 v167, v167
    v_mfma_f32_32x32x16_bf16 v[112:127], v[244:247], v[228:231], v[112:127]
    v_exp_f32_e64 v168, v168
    v_cvt_pk_bf16_f32 v216, v160, v161
    v_cvt_pk_bf16_f32 v217, v162, v163
    v_cvt_pk_bf16_f32 v218, v164, v165
    v_cvt_pk_bf16_f32 v219, v166, v167
    v_exp_f32 v169, v169
    v_exp_f32 v170, v170
    v_mfma_f32_32x32x16_bf16 v[176:191], v[208:211], v[216:219], v[176:191]
    v_exp_f32 v171, v171
    v_exp_f32 v172, v172
    v_exp_f32 v173, v173
    v_exp_f32 v174, v174
    v_exp_f32_e64 v175, v175
    buffer_load_dwordx4 v[228:231], v3, s[16:19], s71 offen offset:2048 sc1
    v_cvt_pk_bf16_f32 v220, v168, v169
    v_cvt_pk_bf16_f32 v221, v170, v171
    v_cvt_pk_bf16_f32 v222, v172, v173
    v_cvt_pk_bf16_f32 v223, v174, v175
    v_exp_f32 v144, v144
    s_waitcnt lgkmcnt(0)
    s_add_u32 m0, s42, 2048
    s_add_u32 s44, s72, 180224
    buffer_load_dwordx4 v10, s[20:23], s44 offen lds
    s_add_u32 s44, s44, 7168
    buffer_load_dwordx4 v10, s[20:23], s44 offen offset:1024 lds
    v_mfma_f32_32x32x16_bf16 v[160:175], v[196:199], v[4:7], v[128:143]
    ds_read_b128 v[192:195], v8 offset:49152
    v_exp_f32 v145, v145
    v_exp_f32 v146, v146
    v_exp_f32 v147, v147
    v_exp_f32 v148, v148
    v_mfma_f32_32x32x16_bf16 v[176:191], v[212:215], v[220:223], v[176:191]
    v_exp_f32 v149, v149
    s_mov_b64 exec, s[50:51]
    ds_read_b128 v[208:211], v9 offset:47104
    ds_read_b128 v[212:215], v9 offset:47616
    s_mov_b64 exec, -1
    v_exp_f32 v150, v150
    v_exp_f32 v151, v151
    s_waitcnt vmcnt(7)
    v_mfma_f32_32x32x16_bf16 v[64:79], v[248:251], v[232:235], v[64:79]
    v_exp_f32_e64 v152, v152
    v_cvt_pk_bf16_f32 v216, v144, v145
    v_cvt_pk_bf16_f32 v217, v146, v147
    v_cvt_pk_bf16_f32 v218, v148, v149
    v_cvt_pk_bf16_f32 v219, v150, v151
    v_exp_f32 v153, v153
    v_exp_f32 v154, v154
    v_mfma_f32_32x32x16_bf16 v[176:191], v[200:203], v[216:219], v[176:191]
    v_exp_f32 v155, v155
    v_exp_f32 v156, v156
    v_exp_f32_e64 v157, v157
    v_mfma_f32_32x32x16_bf16 v[80:95], v[252:255], v[232:235], v[80:95]
    v_exp_f32 v158, v158
    v_exp_f32 v159, v159
    buffer_load_dwordx4 v[232:235], v3, s[16:19], s70 offen offset:3072 sc1
    s_add_u32 s70, s70, 4096
    v_cvt_pk_bf16_f32 v220, v152, v153
    v_cvt_pk_bf16_f32 v221, v154, v155
    v_cvt_pk_bf16_f32 v222, v156, v157
    v_cvt_pk_bf16_f32 v223, v158, v159
    v_exp_f32_e64 v160, v160
    s_waitcnt lgkmcnt(0)
    s_setprio 0
    v_mfma_f32_32x32x16_bf16 v[144:159], v[192:195], v[4:7], v[128:143]
    ds_read_b128 v[196:199], v8 offset:51200
    v_exp_f32 v161, v161
    v_exp_f32 v162, v162
    v_exp_f32 v163, v163
    v_exp_f32 v164, v164
    v_mfma_f32_32x32x16_bf16 v[176:191], v[204:207], v[220:223], v[176:191]
    v_exp_f32 v165, v165
    s_mov_b64 exec, s[50:51]
    ds_read_b128 v[200:203], v9 offset:49152
    ds_read_b128 v[204:207], v9 offset:49664
    s_mov_b64 exec, -1
    v_exp_f32 v166, v166
    v_exp_f32 v167, v167
    v_exp_f32 v168, v168
    v_cvt_pk_bf16_f32 v216, v160, v161
    v_cvt_pk_bf16_f32 v217, v162, v163
    v_cvt_pk_bf16_f32 v218, v164, v165
    v_cvt_pk_bf16_f32 v219, v166, v167
    v_exp_f32 v169, v169
    v_exp_f32 v170, v170
    v_mfma_f32_32x32x16_bf16 v[176:191], v[208:211], v[216:219], v[176:191]
    v_exp_f32 v171, v171
    v_exp_f32 v172, v172
    v_exp_f32 v173, v173
    s_waitcnt vmcnt(7)
    v_mfma_f32_32x32x16_bf16 v[96:111], v[248:251], v[236:239], v[96:111]
    v_exp_f32 v174, v174
    v_exp_f32 v175, v175
    v_cvt_pk_bf16_f32 v220, v168, v169
    v_cvt_pk_bf16_f32 v221, v170, v171
    v_cvt_pk_bf16_f32 v222, v172, v173
    v_cvt_pk_bf16_f32 v223, v174, v175
    v_add_u32 v8, 49152, v8
    v_add_u32 v9, 49152, v9
    v_exp_f32 v144, v144
    s_waitcnt lgkmcnt(0)
    s_barrier
    s_setprio 3
    v_mfma_f32_32x32x16_bf16 v[160:175], v[196:199], v[4:7], v[128:143]
    ds_read_b128 v[192:195], v8 offset:4096
    v_exp_f32 v145, v145
    v_exp_f32 v146, v146
    v_exp_f32 v147, v147
    v_exp_f32 v148, v148
    v_mfma_f32_32x32x16_bf16 v[176:191], v[212:215], v[220:223], v[176:191]
    v_exp_f32 v149, v149
    s_mov_b64 exec, s[50:51]
    ds_read_b128 v[208:211], v9 offset:2048
    ds_read_b128 v[212:215], v9 offset:2560
    s_mov_b64 exec, -1
    s_waitcnt vmcnt(5)
    ds_read_b64_tr_b16 v[240:241], v11 offset:0
    ds_read_b64_tr_b16 v[242:243], v11 offset:1024
    ds_read_b64_tr_b16 v[244:245], v15 offset:0
    ds_read_b64_tr_b16 v[246:247], v15 offset:1024
    v_exp_f32 v150, v150
    v_exp_f32 v151, v151
    v_mfma_f32_32x32x16_bf16 v[112:127], v[252:255], v[236:239], v[112:127]
    v_exp_f32_e64 v152, v152
    v_cvt_pk_bf16_f32 v216, v144, v145
    v_cvt_pk_bf16_f32 v217, v146, v147
    v_cvt_pk_bf16_f32 v218, v148, v149
    v_cvt_pk_bf16_f32 v219, v150, v151
    v_exp_f32 v153, v153
    v_exp_f32 v154, v154
    v_mfma_f32_32x32x16_bf16 v[176:191], v[200:203], v[216:219], v[176:191]
    v_exp_f32 v155, v155
    v_exp_f32 v156, v156
    v_exp_f32_e64 v157, v157
    s_lshl_b32 s45, s36, 13
    s_add_u32 m0, s45, 0
    s_lshl_b32 s44, s36, 16
    s_add_u32 s44, s44, 0
    buffer_load_dwordx4 v10, s[24:27], s44 offen lds
    v_exp_f32 v158, v158
    v_exp_f32 v159, v159
    buffer_load_dwordx4 v[236:239], v3, s[16:19], s71 offen offset:3072 sc1
    s_add_u32 s71, s71, 4096
    s_lshl_b32 s44, s75, 12
    s_add_u32 s44, s44, 15728640
    v_and_b32 v18, 31, v2
    v_lshlrev_b32_e64 v18, 7, v18
    buffer_load_dword v14, v18, s[16:19], s44 offen sc1
    v_cvt_pk_bf16_f32 v220, v152, v153
    v_cvt_pk_bf16_f32 v221, v154, v155
    v_cvt_pk_bf16_f32 v222, v156, v157
    v_cvt_pk_bf16_f32 v223, v158, v159
    v_exp_f32_e64 v160, v160
    s_waitcnt lgkmcnt(0)
    s_add_u32 m0, s42, 0
    s_add_u32 s44, s72, 196608
    buffer_load_dwordx4 v10, s[20:23], s44 offen lds
    s_add_u32 s44, s44, 7168
    buffer_load_dwordx4 v10, s[20:23], s44 offen offset:1024 lds
    v_mfma_f32_32x32x16_bf16 v[144:159], v[192:195], v[4:7], v[128:143]
    ds_read_b128 v[196:199], v8 offset:6144
    v_exp_f32 v161, v161
    v_exp_f32 v162, v162
    v_exp_f32 v163, v163
    v_exp_f32 v164, v164
    v_mfma_f32_32x32x16_bf16 v[176:191], v[204:207], v[220:223], v[176:191]
    v_exp_f32 v165, v165
    s_mov_b64 exec, s[50:51]
    ds_read_b128 v[200:203], v9 offset:4096
    ds_read_b128 v[204:207], v9 offset:4608
    s_mov_b64 exec, -1
    v_exp_f32 v166, v166
    v_exp_f32 v167, v167
    s_waitcnt vmcnt(9)
    v_mfma_f32_32x32x16_bf16 v[64:79], v[240:243], v[224:227], v[64:79]
    v_exp_f32_e64 v168, v168
    v_cvt_pk_bf16_f32 v216, v160, v161
    v_cvt_pk_bf16_f32 v217, v162, v163
    v_cvt_pk_bf16_f32 v218, v164, v165
    v_cvt_pk_bf16_f32 v219, v166, v167
    v_exp_f32 v169, v169
    v_exp_f32 v170, v170
    v_mfma_f32_32x32x16_bf16 v[176:191], v[208:211], v[216:219], v[176:191]
    v_exp_f32 v171, v171
    v_exp_f32 v172, v172
    v_exp_f32_e64 v173, v173
    v_mfma_f32_32x32x16_bf16 v[80:95], v[244:247], v[224:227], v[80:95]
    s_lshl_b32 s45, s36, 13
    s_add_u32 m0, s45, 1024
    s_lshl_b32 s44, s36, 16
    s_add_u32 s44, s44, 8192
    buffer_load_dwordx4 v10, s[24:27], s44 offen lds
    v_exp_f32 v174, v174
    v_exp_f32 v175, v175
    buffer_load_dwordx4 v[224:227], v3, s[16:19], s70 offen offset:0 sc1
    v_cvt_pk_bf16_f32 v220, v168, v169
    v_cvt_pk_bf16_f32 v221, v170, v171
    v_cvt_pk_bf16_f32 v222, v172, v173
    v_cvt_pk_bf16_f32 v223, v174, v175
    v_exp_f32 v144, v144
    s_waitcnt lgkmcnt(0)
    v_mfma_f32_32x32x16_bf16 v[160:175], v[196:199], v[4:7], v[128:143]
    ds_read_b128 v[192:195], v8 offset:8192
    v_exp_f32 v145, v145
    v_exp_f32 v146, v146
    v_exp_f32 v147, v147
    v_exp_f32 v148, v148
    v_mfma_f32_32x32x16_bf16 v[176:191], v[212:215], v[220:223], v[176:191]
    v_exp_f32 v149, v149
    s_mov_b64 exec, s[50:51]
    ds_read_b128 v[208:211], v9 offset:6144
    ds_read_b128 v[212:215], v9 offset:6656
    s_mov_b64 exec, -1
    v_exp_f32 v150, v150
    v_exp_f32 v151, v151
    v_exp_f32 v152, v152
    v_cvt_pk_bf16_f32 v216, v144, v145
    v_cvt_pk_bf16_f32 v217, v146, v147
    v_cvt_pk_bf16_f32 v218, v148, v149
    v_cvt_pk_bf16_f32 v219, v150, v151
    v_exp_f32 v153, v153
    v_exp_f32 v154, v154
    v_mfma_f32_32x32x16_bf16 v[176:191], v[200:203], v[216:219], v[176:191]
    v_exp_f32 v155, v155
    v_exp_f32 v156, v156
    v_exp_f32 v157, v157
    s_waitcnt vmcnt(10)
    v_mfma_f32_32x32x16_bf16 v[96:111], v[240:243], v[228:231], v[96:111]
    s_lshl_b32 s45, s36, 13
    s_add_u32 m0, s45, 2048
    s_lshl_b32 s44, s36, 16
    s_add_u32 s44, s44, 16384
    buffer_load_dwordx4 v10, s[24:27], s44 offen lds
    v_exp_f32 v158, v158
    v_exp_f32 v159, v159
    v_cvt_pk_bf16_f32 v220, v152, v153
    v_cvt_pk_bf16_f32 v221, v154, v155
    v_cvt_pk_bf16_f32 v222, v156, v157
    v_cvt_pk_bf16_f32 v223, v158, v159
    v_exp_f32 v160, v160
    s_waitcnt lgkmcnt(0)
    v_mfma_f32_32x32x16_bf16 v[144:159], v[192:195], v[4:7], v[128:143]
    ds_read_b128 v[196:199], v8 offset:10240
    v_exp_f32 v161, v161
    v_exp_f32 v162, v162
    v_exp_f32 v163, v163
    v_exp_f32 v164, v164
    v_mfma_f32_32x32x16_bf16 v[176:191], v[204:207], v[220:223], v[176:191]
    v_exp_f32 v165, v165
    s_mov_b64 exec, s[50:51]
    ds_read_b128 v[200:203], v9 offset:8192
    ds_read_b128 v[204:207], v9 offset:8704
    s_mov_b64 exec, -1
    s_waitcnt vmcnt(9)
    ds_read_b64_tr_b16 v[248:249], v11 offset:2048
    ds_read_b64_tr_b16 v[250:251], v11 offset:3072
    ds_read_b64_tr_b16 v[252:253], v15 offset:2048
    ds_read_b64_tr_b16 v[254:255], v15 offset:3072
    v_exp_f32 v166, v166
    v_exp_f32 v167, v167
    v_mfma_f32_32x32x16_bf16 v[112:127], v[244:247], v[228:231], v[112:127]
    v_exp_f32_e64 v168, v168
    v_cvt_pk_bf16_f32 v216, v160, v161
    v_cvt_pk_bf16_f32 v217, v162, v163
    v_cvt_pk_bf16_f32 v218, v164, v165
    v_cvt_pk_bf16_f32 v219, v166, v167
    v_exp_f32 v169, v169
    v_exp_f32 v170, v170
    v_mfma_f32_32x32x16_bf16 v[176:191], v[208:211], v[216:219], v[176:191]
    v_exp_f32 v171, v171
    v_exp_f32 v172, v172
    v_exp_f32 v173, v173
    s_lshl_b32 s45, s36, 13
    s_add_u32 m0, s45, 3072
    s_lshl_b32 s44, s36, 16
    s_add_u32 s44, s44, 24576
    buffer_load_dwordx4 v10, s[24:27], s44 offen lds
    v_exp_f32 v174, v174
    v_exp_f32_e64 v175, v175
    buffer_load_dwordx4 v[228:231], v3, s[16:19], s71 offen offset:0 sc1
    v_cvt_pk_bf16_f32 v220, v168, v169
    v_cvt_pk_bf16_f32 v221, v170, v171
    v_cvt_pk_bf16_f32 v222, v172, v173
    v_cvt_pk_bf16_f32 v223, v174, v175
    v_exp_f32 v144, v144
    s_waitcnt lgkmcnt(0)
    s_add_u32 m0, s42, 2048
    s_add_u32 s44, s72, 212992
    buffer_load_dwordx4 v10, s[20:23], s44 offen lds
    s_add_u32 s44, s44, 7168
    buffer_load_dwordx4 v10, s[20:23], s44 offen offset:1024 lds
    v_mfma_f32_32x32x16_bf16 v[160:175], v[196:199], v[4:7], v[128:143]
    ds_read_b128 v[192:195], v8 offset:12288
    v_exp_f32 v145, v145
    v_exp_f32 v146, v146
    v_exp_f32 v147, v147
    v_exp_f32 v148, v148
    v_mfma_f32_32x32x16_bf16 v[176:191], v[212:215], v[220:223], v[176:191]
    v_exp_f32 v149, v149
    s_mov_b64 exec, s[50:51]
    ds_read_b128 v[208:211], v9 offset:10240
    ds_read_b128 v[212:215], v9 offset:10752
    s_mov_b64 exec, -1
    v_exp_f32 v150, v150
    v_exp_f32 v151, v151
    s_waitcnt vmcnt(12)
    v_mfma_f32_32x32x16_bf16 v[64:79], v[248:251], v[232:235], v[64:79]
    v_exp_f32_e64 v152, v152
    v_cvt_pk_bf16_f32 v216, v144, v145
    v_cvt_pk_bf16_f32 v217, v146, v147
    v_cvt_pk_bf16_f32 v218, v148, v149
    v_cvt_pk_bf16_f32 v219, v150, v151
    v_exp_f32 v153, v153
    v_exp_f32 v154, v154
    v_mfma_f32_32x32x16_bf16 v[176:191], v[200:203], v[216:219], v[176:191]
    v_exp_f32 v155, v155
    v_exp_f32 v156, v156
    v_exp_f32_e64 v157, v157
    v_mfma_f32_32x32x16_bf16 v[80:95], v[252:255], v[232:235], v[80:95]
    s_lshl_b32 s45, s36, 13
    s_add_u32 m0, s45, 4096
    s_lshl_b32 s44, s36, 16
    s_add_u32 s44, s44, 32768
    buffer_load_dwordx4 v10, s[24:27], s44 offen lds
    v_exp_f32 v158, v158
    v_exp_f32 v159, v159
    buffer_load_dwordx4 v[232:235], v3, s[16:19], s70 offen offset:1024 sc1
    v_cvt_pk_bf16_f32 v220, v152, v153
    v_cvt_pk_bf16_f32 v221, v154, v155
    v_cvt_pk_bf16_f32 v222, v156, v157
    v_cvt_pk_bf16_f32 v223, v158, v159
    v_exp_f32 v160, v160
    s_waitcnt lgkmcnt(0)
    v_mfma_f32_32x32x16_bf16 v[144:159], v[192:195], v[4:7], v[128:143]
    ds_read_b128 v[196:199], v8 offset:14336
    v_exp_f32 v161, v161
    v_exp_f32 v162, v162
    v_exp_f32 v163, v163
    v_exp_f32 v164, v164
    v_mfma_f32_32x32x16_bf16 v[176:191], v[204:207], v[220:223], v[176:191]
    v_exp_f32 v165, v165
    s_mov_b64 exec, s[50:51]
    ds_read_b128 v[200:203], v9 offset:12288
    ds_read_b128 v[204:207], v9 offset:12800
    s_mov_b64 exec, -1
    v_exp_f32 v166, v166
    v_exp_f32 v167, v167
    v_exp_f32 v168, v168
    v_cvt_pk_bf16_f32 v216, v160, v161
    v_cvt_pk_bf16_f32 v217, v162, v163
    v_cvt_pk_bf16_f32 v218, v164, v165
    v_cvt_pk_bf16_f32 v219, v166, v167
    v_exp_f32 v169, v169
    v_exp_f32 v170, v170
    v_mfma_f32_32x32x16_bf16 v[176:191], v[208:211], v[216:219], v[176:191]
    v_exp_f32 v171, v171
    v_exp_f32 v172, v172
    v_exp_f32 v173, v173
    s_waitcnt vmcnt(12)
    v_mfma_f32_32x32x16_bf16 v[96:111], v[248:251], v[236:239], v[96:111]
    s_lshl_b32 s45, s36, 13
    s_add_u32 m0, s45, 5120
    s_lshl_b32 s44, s36, 16
    s_add_u32 s44, s44, 40960
    buffer_load_dwordx4 v10, s[24:27], s44 offen lds
    v_exp_f32 v174, v174
    v_exp_f32 v175, v175
    v_cvt_pk_bf16_f32 v220, v168, v169
    v_cvt_pk_bf16_f32 v221, v170, v171
    v_cvt_pk_bf16_f32 v222, v172, v173
    v_cvt_pk_bf16_f32 v223, v174, v175
    v_exp_f32 v144, v144
    s_waitcnt lgkmcnt(0)
    v_mfma_f32_32x32x16_bf16 v[160:175], v[196:199], v[4:7], v[128:143]
    ds_read_b128 v[192:195], v8 offset:16384
    v_exp_f32 v145, v145
    v_exp_f32 v146, v146
    v_exp_f32 v147, v147
    v_exp_f32 v148, v148
    v_mfma_f32_32x32x16_bf16 v[176:191], v[212:215], v[220:223], v[176:191]
    v_exp_f32 v149, v149
    s_mov_b64 exec, s[50:51]
    ds_read_b128 v[208:211], v9 offset:14336
    ds_read_b128 v[212:215], v9 offset:14848
    s_mov_b64 exec, -1
    s_waitcnt vmcnt(10)
    ds_read_b64_tr_b16 v[240:241], v11 offset:0
    ds_read_b64_tr_b16 v[242:243], v11 offset:1024
    ds_read_b64_tr_b16 v[244:245], v15 offset:0
    ds_read_b64_tr_b16 v[246:247], v15 offset:1024
    v_exp_f32 v150, v150
    v_exp_f32 v151, v151
    v_mfma_f32_32x32x16_bf16 v[112:127], v[252:255], v[236:239], v[112:127]
    v_exp_f32_e64 v152, v152
    v_cvt_pk_bf16_f32 v216, v144, v145
    v_cvt_pk_bf16_f32 v217, v146, v147
    v_cvt_pk_bf16_f32 v218, v148, v149
    v_cvt_pk_bf16_f32 v219, v150, v151
    v_exp_f32 v153, v153
    v_exp_f32 v154, v154
    v_mfma_f32_32x32x16_bf16 v[176:191], v[200:203], v[216:219], v[176:191]
    v_exp_f32 v155, v155
    v_exp_f32 v156, v156
    v_exp_f32 v157, v157
    s_lshl_b32 s45, s36, 13
    s_add_u32 m0, s45, 6144
    s_lshl_b32 s44, s36, 16
    s_add_u32 s44, s44, 49152
    buffer_load_dwordx4 v10, s[24:27], s44 offen lds
    v_exp_f32 v158, v158
    v_exp_f32_e64 v159, v159
    buffer_load_dwordx4 v[236:239], v3, s[16:19], s71 offen offset:1024 sc1
    v_cvt_pk_bf16_f32 v220, v152, v153
    v_cvt_pk_bf16_f32 v221, v154, v155
    v_cvt_pk_bf16_f32 v222, v156, v157
    v_cvt_pk_bf16_f32 v223, v158, v159
    v_exp_f32 v160, v160
    s_waitcnt lgkmcnt(0)
    v_mfma_f32_32x32x16_bf16 v[144:159], v[192:195], v[4:7], v[128:143]
    ds_read_b128 v[196:199], v8 offset:18432
    v_exp_f32 v161, v161
    v_exp_f32 v162, v162
    v_exp_f32 v163, v163
    v_exp_f32 v164, v164
    v_mfma_f32_32x32x16_bf16 v[176:191], v[204:207], v[220:223], v[176:191]
    v_exp_f32 v165, v165
    s_mov_b64 exec, s[50:51]
    ds_read_b128 v[200:203], v9 offset:16384
    ds_read_b128 v[204:207], v9 offset:16896
    s_mov_b64 exec, -1
    v_exp_f32 v166, v166
    v_exp_f32 v167, v167
    s_waitcnt vmcnt(10)
    v_mfma_f32_32x32x16_bf16 v[64:79], v[240:243], v[224:227], v[64:79]
    v_exp_f32_e64 v168, v168
    v_cvt_pk_bf16_f32 v216, v160, v161
    v_cvt_pk_bf16_f32 v217, v162, v163
    v_cvt_pk_bf16_f32 v218, v164, v165
    v_cvt_pk_bf16_f32 v219, v166, v167
    v_exp_f32 v169, v169
    v_exp_f32 v170, v170
    v_mfma_f32_32x32x16_bf16 v[176:191], v[208:211], v[216:219], v[176:191]
    v_exp_f32 v171, v171
    v_exp_f32 v172, v172
    v_exp_f32_e64 v173, v173
    v_mfma_f32_32x32x16_bf16 v[80:95], v[244:247], v[224:227], v[80:95]
    s_lshl_b32 s45, s36, 13
    s_add_u32 m0, s45, 7168
    s_lshl_b32 s44, s36, 16
    s_add_u32 s44, s44, 57344
    buffer_load_dwordx4 v10, s[24:27], s44 offen lds
    v_exp_f32 v174, v174
    v_exp_f32 v175, v175
    v_cvt_pk_bf16_f32 v220, v168, v169
    v_cvt_pk_bf16_f32 v221, v170, v171
    v_cvt_pk_bf16_f32 v222, v172, v173
    v_cvt_pk_bf16_f32 v223, v174, v175
    v_exp_f32 v144, v144
    s_waitcnt lgkmcnt(0)
    v_mfma_f32_32x32x16_bf16 v[160:175], v[196:199], v[4:7], v[128:143]
    ds_read_b128 v[192:195], v8 offset:20480
    v_exp_f32 v145, v145
    v_exp_f32 v146, v146
    v_exp_f32 v147, v147
    v_exp_f32 v148, v148
    v_mfma_f32_32x32x16_bf16 v[176:191], v[212:215], v[220:223], v[176:191]
    v_exp_f32 v149, v149
    s_mov_b64 exec, s[50:51]
    ds_read_b128 v[208:211], v9 offset:18432
    ds_read_b128 v[212:215], v9 offset:18944
    s_mov_b64 exec, -1
    v_exp_f32 v150, v150
    v_exp_f32 v151, v151
    v_exp_f32 v152, v152
    v_cvt_pk_bf16_f32 v216, v144, v145
    v_cvt_pk_bf16_f32 v217, v146, v147
    v_cvt_pk_bf16_f32 v218, v148, v149
    v_cvt_pk_bf16_f32 v219, v150, v151
    v_exp_f32 v153, v153
    v_exp_f32 v154, v154
    v_mfma_f32_32x32x16_bf16 v[176:191], v[200:203], v[216:219], v[176:191]
    v_exp_f32 v155, v155
    v_exp_f32 v156, v156
    v_exp_f32 v157, v157
    s_waitcnt vmcnt(8)
    v_mfma_f32_32x32x16_bf16 v[96:111], v[240:243], v[228:231], v[96:111]
    v_exp_f32 v158, v158
    v_exp_f32 v159, v159
    v_cvt_pk_bf16_f32 v220, v152, v153
    v_cvt_pk_bf16_f32 v221, v154, v155
    v_cvt_pk_bf16_f32 v222, v156, v157
    v_cvt_pk_bf16_f32 v223, v158, v159
    v_exp_f32 v160, v160
    s_waitcnt lgkmcnt(0)
    v_mfma_f32_32x32x16_bf16 v[144:159], v[192:195], v[4:7], v[128:143]
    ds_read_b128 v[196:199], v8 offset:22528
    v_exp_f32 v161, v161
    v_exp_f32 v162, v162
    v_exp_f32 v163, v163
    v_exp_f32 v164, v164
    v_mfma_f32_32x32x16_bf16 v[176:191], v[204:207], v[220:223], v[176:191]
    v_exp_f32 v165, v165
    s_mov_b64 exec, s[50:51]
    ds_read_b128 v[200:203], v9 offset:20480
    ds_read_b128 v[204:207], v9 offset:20992
    s_mov_b64 exec, -1
    s_waitcnt vmcnt(6)
    ds_read_b64_tr_b16 v[248:249], v11 offset:2048
    ds_read_b64_tr_b16 v[250:251], v11 offset:3072
    ds_read_b64_tr_b16 v[252:253], v15 offset:2048
    ds_read_b64_tr_b16 v[254:255], v15 offset:3072
    v_exp_f32 v166, v166
    v_exp_f32 v167, v167
    v_mfma_f32_32x32x16_bf16 v[112:127], v[244:247], v[228:231], v[112:127]
    v_exp_f32_e64 v168, v168
    v_cvt_pk_bf16_f32 v216, v160, v161
    v_cvt_pk_bf16_f32 v217, v162, v163
    v_cvt_pk_bf16_f32 v218, v164, v165
    v_cvt_pk_bf16_f32 v219, v166, v167
    v_exp_f32 v169, v169
    v_exp_f32 v170, v170
    v_mfma_f32_32x32x16_bf16 v[176:191], v[208:211], v[216:219], v[176:191]
    v_exp_f32 v171, v171
    v_exp_f32 v172, v172
    v_exp_f32 v173, v173
    v_exp_f32 v174, v174
    v_exp_f32_e64 v175, v175
    v_cvt_pk_bf16_f32 v220, v168, v169
    v_cvt_pk_bf16_f32 v221, v170, v171
    v_cvt_pk_bf16_f32 v222, v172, v173
    v_cvt_pk_bf16_f32 v223, v174, v175
    v_exp_f32 v144, v144
    s_waitcnt lgkmcnt(0)
    v_mfma_f32_32x32x16_bf16 v[160:175], v[196:199], v[4:7], v[128:143]
    ds_read_b128 v[192:195], v8 offset:24576
    v_exp_f32 v145, v145
    v_exp_f32 v146, v146
    v_exp_f32 v147, v147
    v_exp_f32 v148, v148
    v_mfma_f32_32x32x16_bf16 v[176:191], v[212:215], v[220:223], v[176:191]
    v_exp_f32 v149, v149
    s_mov_b64 exec, s[50:51]
    ds_read_b128 v[208:211], v9 offset:22528
    ds_read_b128 v[212:215], v9 offset:23040
    s_mov_b64 exec, -1
    v_exp_f32 v150, v150
    v_exp_f32 v151, v151
    s_waitcnt vmcnt(4)
    v_mfma_f32_32x32x16_bf16 v[64:79], v[248:251], v[232:235], v[64:79]
    v_exp_f32_e64 v152, v152
    v_cvt_pk_bf16_f32 v216, v144, v145
    v_cvt_pk_bf16_f32 v217, v146, v147
    v_cvt_pk_bf16_f32 v218, v148, v149
    v_cvt_pk_bf16_f32 v219, v150, v151
    v_exp_f32 v153, v153
    v_exp_f32 v154, v154
    v_mfma_f32_32x32x16_bf16 v[176:191], v[200:203], v[216:219], v[176:191]
    v_exp_f32 v155, v155
    v_exp_f32 v156, v156
    v_exp_f32_e64 v157, v157
    v_mfma_f32_32x32x16_bf16 v[80:95], v[252:255], v[232:235], v[80:95]
    v_exp_f32 v158, v158
    v_exp_f32 v159, v159
    v_cvt_pk_bf16_f32 v220, v152, v153
    v_cvt_pk_bf16_f32 v221, v154, v155
    v_cvt_pk_bf16_f32 v222, v156, v157
    v_cvt_pk_bf16_f32 v223, v158, v159
    v_exp_f32_e64 v160, v160
    s_waitcnt lgkmcnt(0)
    s_setprio 2
    v_mfma_f32_32x32x16_bf16 v[144:159], v[192:195], v[4:7], v[128:143]
    ds_read_b128 v[196:199], v8 offset:26624
    v_exp_f32 v161, v161
    v_exp_f32 v162, v162
    v_exp_f32 v163, v163
    v_exp_f32 v164, v164
    v_mfma_f32_32x32x16_bf16 v[176:191], v[204:207], v[220:223], v[176:191]
    v_exp_f32 v165, v165
    s_mov_b64 exec, s[50:51]
    ds_read_b128 v[200:203], v9 offset:24576
    ds_read_b128 v[204:207], v9 offset:25088
    s_mov_b64 exec, -1
    v_exp_f32 v166, v166
    v_exp_f32 v167, v167
    v_exp_f32 v168, v168
    v_cvt_pk_bf16_f32 v216, v160, v161
    v_cvt_pk_bf16_f32 v217, v162, v163
    v_cvt_pk_bf16_f32 v218, v164, v165
    v_cvt_pk_bf16_f32 v219, v166, v167
    v_exp_f32 v169, v169
    v_exp_f32 v170, v170
    v_mfma_f32_32x32x16_bf16 v[176:191], v[208:211], v[216:219], v[176:191]
    v_exp_f32 v171, v171
    v_exp_f32 v172, v172
    v_exp_f32 v173, v173
    s_waitcnt vmcnt(1)
    v_mfma_f32_32x32x16_bf16 v[96:111], v[248:251], v[236:239], v[96:111]
    v_exp_f32 v174, v174
    v_exp_f32_e64 v175, v175
    s_lshl_b32 s71, s75, 15
    s_lshl_b32 s45, s52, 13
    s_add_u32 s71, s71, s45
    s_add_u32 s71, s71, 6291456
    s_add_u32 s83, s71, 4096
    v_cvt_pk_bf16_f32 v220, v168, v169
    v_cvt_pk_bf16_f32 v221, v170, v171
    v_cvt_pk_bf16_f32 v222, v172, v173
    v_cvt_pk_bf16_f32 v223, v174, v175
    v_exp_f32 v144, v144
    s_waitcnt lgkmcnt(0)
    v_mfma_f32_32x32x16_bf16 v[160:175], v[196:199], v[4:7], v[128:143]
    ds_read_b128 v[192:195], v8 offset:28672
    v_exp_f32 v145, v145
    v_exp_f32 v146, v146
    v_exp_f32 v147, v147
    v_exp_f32 v148, v148
    v_mfma_f32_32x32x16_bf16 v[176:191], v[212:215], v[220:223], v[176:191]
    v_exp_f32 v149, v149
    s_mov_b64 exec, s[50:51]
    ds_read_b128 v[208:211], v9 offset:26624
    ds_read_b128 v[212:215], v9 offset:27136
    s_mov_b64 exec, -1
    v_exp_f32 v150, v150
    v_exp_f32_e64 v151, v151
    v_mfma_f32_32x32x16_bf16 v[112:127], v[252:255], v[236:239], v[112:127]
    v_exp_f32_e64 v152, v152
    v_cvt_pk_bf16_f32 v216, v144, v145
    v_cvt_pk_bf16_f32 v217, v146, v147
    v_cvt_pk_bf16_f32 v218, v148, v149
    v_cvt_pk_bf16_f32 v219, v150, v151
    v_exp_f32 v153, v153
    v_exp_f32 v154, v154
    v_mfma_f32_32x32x16_bf16 v[176:191], v[200:203], v[216:219], v[176:191]
    v_exp_f32 v155, v155
    v_exp_f32 v156, v156
    v_exp_f32 v157, v157
    v_exp_f32 v158, v158
    v_exp_f32 v159, v159
    v_add_u32 v12, s42, v3
    v_subrev_u32 v13, 65536, v12
    v_cvt_pk_bf16_f32 v220, v152, v153
    v_cvt_pk_bf16_f32 v221, v154, v155
    v_cvt_pk_bf16_f32 v222, v156, v157
    v_cvt_pk_bf16_f32 v223, v158, v159
    v_exp_f32 v160, v160
    s_waitcnt lgkmcnt(0)
    v_mfma_f32_32x32x16_bf16 v[144:159], v[192:195], v[4:7], v[128:143]
    ds_read_b128 v[196:199], v8 offset:30720
    v_exp_f32 v161, v161
    v_exp_f32 v162, v162
    v_exp_f32 v163, v163
    v_exp_f32 v164, v164
    v_mfma_f32_32x32x16_bf16 v[176:191], v[204:207], v[220:223], v[176:191]
    v_exp_f32 v165, v165
    s_mov_b64 exec, s[50:51]
    ds_read_b128 v[200:203], v9 offset:28672
    ds_read_b128 v[204:207], v9 offset:29184
    s_mov_b64 exec, -1
    ds_write_b128 v12, v[96:99] offset:0
    v_exp_f32 v166, v166
    v_exp_f32 v167, v167
    v_exp_f32 v168, v168
    v_cvt_pk_bf16_f32 v216, v160, v161
    v_cvt_pk_bf16_f32 v217, v162, v163
    v_cvt_pk_bf16_f32 v218, v164, v165
    v_cvt_pk_bf16_f32 v219, v166, v167
    v_exp_f32 v169, v169
    v_exp_f32 v170, v170
    v_mfma_f32_32x32x16_bf16 v[176:191], v[208:211], v[216:219], v[176:191]
    v_exp_f32 v171, v171
    v_exp_f32 v172, v172
    v_exp_f32_e64 v173, v173
    ds_write_b128 v12, v[100:103] offset:1024
    v_exp_f32 v174, v174
    v_exp_f32 v175, v175
    ds_write_b128 v12, v[104:107] offset:2048
    v_cvt_pk_bf16_f32 v220, v168, v169
    v_cvt_pk_bf16_f32 v221, v170, v171
    v_cvt_pk_bf16_f32 v222, v172, v173
    v_cvt_pk_bf16_f32 v223, v174, v175
    v_exp_f32_e64 v144, v144
    s_waitcnt lgkmcnt(0)
    s_setprio 1
    v_mfma_f32_32x32x16_bf16 v[160:175], v[196:199], v[4:7], v[128:143]
    v_exp_f32 v145, v145
    v_exp_f32 v146, v146
    v_exp_f32 v147, v147
    v_exp_f32 v148, v148
    v_mfma_f32_32x32x16_bf16 v[176:191], v[212:215], v[220:223], v[176:191]
    v_exp_f32 v149, v149
    s_mov_b64 exec, s[50:51]
    ds_read_b128 v[208:211], v9 offset:30720
    ds_read_b128 v[212:215], v9 offset:31232
    s_mov_b64 exec, -1
    ds_write_b128 v12, v[108:111] offset:3072
    v_exp_f32 v150, v150
    v_exp_f32 v151, v151
    v_exp_f32 v152, v152
    v_cvt_pk_bf16_f32 v216, v144, v145
    v_cvt_pk_bf16_f32 v217, v146, v147
    v_cvt_pk_bf16_f32 v218, v148, v149
    v_cvt_pk_bf16_f32 v219, v150, v151
    v_exp_f32 v153, v153
    v_exp_f32 v154, v154
    v_mfma_f32_32x32x16_bf16 v[176:191], v[200:203], v[216:219], v[176:191]
    v_exp_f32 v155, v155
    v_exp_f32 v156, v156
    v_exp_f32_e64 v157, v157
    ds_write_b128 v13, v[112:115] offset:0
    v_exp_f32 v158, v158
    v_exp_f32 v159, v159
    ds_write_b128 v13, v[116:119] offset:1024
    v_cvt_pk_bf16_f32 v220, v152, v153
    v_cvt_pk_bf16_f32 v221, v154, v155
    v_cvt_pk_bf16_f32 v222, v156, v157
    v_cvt_pk_bf16_f32 v223, v158, v159
    v_exp_f32 v160, v160
    s_waitcnt lgkmcnt(0)
    s_setprio 0
    v_exp_f32 v161, v161
    v_exp_f32 v162, v162
    v_exp_f32 v163, v163
    v_exp_f32_e64 v164, v164
    v_mfma_f32_32x32x16_bf16 v[176:191], v[204:207], v[220:223], v[176:191]
    v_exp_f32_e64 v165, v165
    ds_write_b128 v13, v[120:123] offset:2048
    v_exp_f32 v166, v166
    v_exp_f32 v167, v167
    v_exp_f32_e64 v168, v168
    v_cvt_pk_bf16_f32 v216, v160, v161
    v_cvt_pk_bf16_f32 v217, v162, v163
    v_cvt_pk_bf16_f32 v218, v164, v165
    v_cvt_pk_bf16_f32 v219, v166, v167
    v_exp_f32 v169, v169
    v_exp_f32 v170, v170
    v_mfma_f32_32x32x16_bf16 v[176:191], v[208:211], v[216:219], v[176:191]
    v_exp_f32 v171, v171
    v_exp_f32 v172, v172
    v_exp_f32_e64 v173, v173
    ds_write_b128 v13, v[124:127] offset:3072
    v_exp_f32 v174, v174
    v_exp_f32 v175, v175
    v_cvt_pk_bf16_f32 v220, v168, v169
    v_cvt_pk_bf16_f32 v221, v170, v171
    v_cvt_pk_bf16_f32 v222, v172, v173
    v_cvt_pk_bf16_f32 v223, v174, v175
    s_nop 1
    v_mfma_f32_32x32x16_bf16 v[176:191], v[212:215], v[220:223], v[176:191]
    s_mov_b32 s44, 0x53800000
    s_nop 3
    v_mov_b32_e64 v18, v184
    v_fma_f32 v18, v176, 0, v18
    v_fma_f32 v18, v177, 0, v18
    v_fma_f32 v18, v178, 0, v18
    v_fma_f32 v18, v179, 0, v18
    v_fma_f32 v18, v180, 0, v18
    v_fma_f32 v18, v181, 0, v18
    v_fma_f32 v18, v182, 0, v18
    v_fma_f32 v18, v183, 0, v18
    v_cmp_gt_f32 vcc, s44, v18
    s_cmp_eq_u64 vcc, exec
    s_cbranch_scc0 L_slow
L_fin:
    v_rcp_f32 v18, v184
    s_nop 0
    v_mul_f32 v176, v176, v18
    v_mul_f32 v177, v177, v18
    v_mul_f32 v178, v178, v18
    v_mul_f32 v179, v179, v18
    v_mul_f32 v180, v180, v18
    v_mul_f32 v181, v181, v18
    v_mul_f32 v182, v182, v18
    v_mul_f32_e64 v183, v183, v18
    v_cvt_pk_bf16_f32 v224, v176, v177
    v_cvt_pk_bf16_f32 v225, v178, v179
    v_cvt_pk_bf16_f32 v226, v180, v181
    v_cvt_pk_bf16_f32 v227, v182, v183
    buffer_store_dwordx4 v[224:227], v3, s[16:19], s84 offen sc1
    v_add_u32_e64 v22, s42, v3
    v_xor_b32 v22, 4096, v22
    v_subrev_u32 v23, 65536, v22
    s_lshl_b32 s44, s52, 14
    s_sub_u32 s44, s44, s42
    v_add_u32 v11, s44, v11
    v_add_u32_e64 v15, s44, v15
    s_waitcnt vmcnt(1)
    s_waitcnt lgkmcnt(0)
    s_barrier
    ds_read_b128 v[96:99], v22 offset:0
    ds_read_b128 v[100:103], v22 offset:1024
    ds_read_b128 v[104:107], v22 offset:2048
    ds_read_b128 v[108:111], v22 offset:3072
    ds_read_b128 v[112:115], v23 offset:0
    ds_read_b128 v[116:119], v23 offset:1024
    ds_read_b128 v[120:123], v23 offset:2048
    ds_read_b128 v[124:127], v23 offset:3072
    ds_read_b64_tr_b16 v[128:129], v11 offset:0
    ds_read_b64_tr_b16 v[130:131], v11 offset:1024
    ds_read_b64_tr_b16 v[132:133], v15 offset:0
    ds_read_b64_tr_b16 v[134:135], v15 offset:1024
    buffer_load_dwordx4 v[32:35], v3, s[16:19], s71 offen offset:0 sc1
    buffer_load_dwordx4 v[36:39], v3, s[16:19], s71 offen offset:1024 sc1
    buffer_load_dwordx4 v[40:43], v3, s[16:19], s71 offen offset:2048 sc1
    buffer_load_dwordx4 v[44:47], v3, s[16:19], s71 offen offset:3072 sc1
    buffer_load_dwordx4 v[48:51], v3, s[16:19], s83 offen offset:0 sc1
    buffer_load_dwordx4 v[52:55], v3, s[16:19], s83 offen offset:1024 sc1
    buffer_load_dwordx4 v[56:59], v3, s[16:19], s83 offen offset:2048 sc1
    buffer_load_dwordx4 v[60:63], v3, s[16:19], s83 offen offset:3072 sc1
    v_sub_f32 v16, 1.0, v14
    s_waitcnt lgkmcnt(0)
    ds_read_b64_tr_b16 v[136:137], v11 offset:2048
    ds_read_b64_tr_b16 v[138:139], v11 offset:3072
    ds_read_b64_tr_b16 v[140:141], v15 offset:2048
    ds_read_b64_tr_b16 v[142:143], v15 offset:3072
    ds_read_b64_tr_b16 v[144:145], v11 offset:4096
    ds_read_b64_tr_b16 v[146:147], v11 offset:5120
    ds_read_b64_tr_b16 v[148:149], v15 offset:4096
    ds_read_b64_tr_b16 v[150:151], v15 offset:5120
    ds_read_b64_tr_b16 v[152:153], v11 offset:6144
    ds_read_b64_tr_b16 v[154:155], v11 offset:7168
    ds_read_b64_tr_b16 v[156:157], v15 offset:6144
    ds_read_b64_tr_b16 v[158:159], v15 offset:7168
    v_pk_add_f32 v[64:65], v[64:65], v[96:97]
    v_pk_add_f32 v[66:67], v[66:67], v[98:99]
    v_pk_add_f32 v[68:69], v[68:69], v[100:101]
    v_pk_add_f32 v[70:71], v[70:71], v[102:103]
    v_pk_add_f32 v[72:73], v[72:73], v[104:105]
    v_pk_add_f32 v[74:75], v[74:75], v[106:107]
    v_pk_add_f32 v[76:77], v[76:77], v[108:109]
    v_pk_add_f32 v[78:79], v[78:79], v[110:111]
    v_pk_add_f32 v[80:81], v[80:81], v[112:113]
    v_pk_add_f32 v[82:83], v[82:83], v[114:115]
    v_pk_add_f32 v[84:85], v[84:85], v[116:117]
    v_pk_add_f32 v[86:87], v[86:87], v[118:119]
    v_pk_add_f32 v[88:89], v[88:89], v[120:121]
    v_pk_add_f32 v[90:91], v[90:91], v[122:123]
    v_pk_add_f32 v[92:93], v[92:93], v[124:125]
    v_pk_add_f32 v[94:95], v[94:95], v[126:127]
    s_waitcnt lgkmcnt(0)
    ds_read_b64_tr_b16 v[160:161], v11 offset:8192
    ds_read_b64_tr_b16 v[162:163], v11 offset:9216
    ds_read_b64_tr_b16 v[164:165], v15 offset:8192
    ds_read_b64_tr_b16 v[166:167], v15 offset:9216
    ds_read_b64_tr_b16 v[168:169], v11 offset:10240
    ds_read_b64_tr_b16 v[170:171], v11 offset:11264
    ds_read_b64_tr_b16 v[172:173], v15 offset:10240
    ds_read_b64_tr_b16 v[174:175], v15 offset:11264
    ds_read_b64_tr_b16 v[176:177], v11 offset:12288
    ds_read_b64_tr_b16 v[178:179], v11 offset:13312
    ds_read_b64_tr_b16 v[180:181], v15 offset:12288
    ds_read_b64_tr_b16 v[182:183], v15 offset:13312
    v_pk_mul_f32 v[64:65], v[64:65], v[16:17] op_sel_hi:[1,0]
    v_pk_mul_f32 v[66:67], v[66:67], v[16:17] op_sel_hi:[1,0]
    v_pk_mul_f32 v[68:69], v[68:69], v[16:17] op_sel_hi:[1,0]
    v_pk_mul_f32 v[70:71], v[70:71], v[16:17] op_sel_hi:[1,0]
    v_pk_mul_f32 v[72:73], v[72:73], v[16:17] op_sel_hi:[1,0]
    v_pk_mul_f32 v[74:75], v[74:75], v[16:17] op_sel_hi:[1,0]
    v_pk_mul_f32 v[76:77], v[76:77], v[16:17] op_sel_hi:[1,0]
    v_pk_mul_f32 v[78:79], v[78:79], v[16:17] op_sel_hi:[1,0]
    v_pk_mul_f32 v[80:81], v[80:81], v[16:17] op_sel_hi:[1,0]
    v_pk_mul_f32 v[82:83], v[82:83], v[16:17] op_sel_hi:[1,0]
    v_pk_mul_f32 v[84:85], v[84:85], v[16:17] op_sel_hi:[1,0]
    v_pk_mul_f32 v[86:87], v[86:87], v[16:17] op_sel_hi:[1,0]
    v_pk_mul_f32 v[88:89], v[88:89], v[16:17] op_sel_hi:[1,0]
    v_pk_mul_f32 v[90:91], v[90:91], v[16:17] op_sel_hi:[1,0]
    v_pk_mul_f32 v[92:93], v[92:93], v[16:17] op_sel_hi:[1,0]
    v_pk_mul_f32 v[94:95], v[94:95], v[16:17] op_sel_hi:[1,0]
    s_waitcnt lgkmcnt(0)
    ds_read_b64_tr_b16 v[184:185], v11 offset:14336
    ds_read_b64_tr_b16 v[186:187], v11 offset:15360
    ds_read_b64_tr_b16 v[188:189], v15 offset:14336
    ds_read_b64_tr_b16 v[190:191], v15 offset:15360
    v_and_b32 v18, 31, v2
    v_lshlrev_b32 v8, 10, v18
    v_lshrrev_b32_e64 v18, 5, v2
    v_lshl_add_u32 v8, v18, 4, v8
    s_lshl_b32 s70, s75, 15
    s_lshl_b32 s45, s49, 7
    s_add_u32 s70, s70, s45
    s_lshl_b32 s45, s52, 5
    s_add_u32 s70, s70, s45
    v_xor_b32 v19, 8192, v23
    v_xor_b32 v20, 16384, v22
    v_xor_b32 v21, 24576, v22
    s_mov_b32 s58, 0x40000
    s_waitcnt lgkmcnt(0)
    s_waitcnt vmcnt(7)
L_oc0:
    v_max3_u32 v12, v32, v33, v34
    v_max_u32 v12, v12, v35
    v_cmp_eq_u32 vcc, -1, v12
    s_cbranch_vccnz L_or0
L_ok0:
    v_mfma_f32_32x32x16_bf16 v[112:127], v[132:135], v[32:35], 0
    v_mfma_f32_32x32x16_bf16 v[96:111], v[128:131], v[32:35], 0
    s_waitcnt vmcnt(6)
L_oc1:
    v_max3_u32 v12, v36, v37, v38
    v_max_u32 v12, v12, v39
    v_cmp_eq_u32 vcc, -1, v12
    s_cbranch_vccnz L_or1
L_ok1:
    v_mfma_f32_32x32x16_bf16 v[112:127], v[140:143], v[36:39], v[112:127]
    v_mfma_f32_32x32x16_bf16 v[96:111], v[136:139], v[36:39], v[96:111]
    s_waitcnt vmcnt(5)
L_oc2:
    v_max3_u32 v12, v40, v41, v42
    v_max_u32 v12, v12, v43
    v_cmp_eq_u32 vcc, -1, v12
    s_cbranch_vccnz L_or2
L_ok2:
    v_mfma_f32_32x32x16_bf16 v[112:127], v[148:151], v[40:43], v[112:127]
    v_mfma_f32_32x32x16_bf16 v[96:111], v[144:147], v[40:43], v[96:111]
    s_waitcnt vmcnt(4)
L_oc3:
    v_max3_u32 v12, v44, v45, v46
    v_max_u32 v12, v12, v47
    v_cmp_eq_u32 vcc, -1, v12
    s_cbranch_vccnz L_or3
L_ok3:
    v_mfma_f32_32x32x16_bf16 v[112:127], v[156:159], v[44:47], v[112:127]
    v_mfma_f32_32x32x16_bf16 v[96:111], v[152:155], v[44:47], v[96:111]
    s_waitcnt vmcnt(3)
L_oc4:
    v_max3_u32 v12, v48, v49, v50
    v_max_u32 v12, v12, v51
    v_cmp_eq_u32 vcc, -1, v12
    s_cbranch_vccnz L_or4
L_ok4:
    v_mfma_f32_32x32x16_bf16 v[112:127], v[164:167], v[48:51], v[112:127]
    v_mfma_f32_32x32x16_bf16 v[96:111], v[160:163], v[48:51], v[96:111]
    s_waitcnt vmcnt(2)
L_oc5:
    v_max3_u32 v12, v52, v53, v54
    v_max_u32 v12, v12, v55
    v_cmp_eq_u32 vcc, -1, v12
    s_cbranch_vccnz L_or5
L_ok5:
    v_mfma_f32_32x32x16_bf16 v[112:127], v[172:175], v[52:55], v[112:127]
    v_mfma_f32_32x32x16_bf16 v[96:111], v[168:171], v[52:55], v[96:111]
    s_waitcnt vmcnt(1)
L_oc6:
    v_max3_u32 v12, v56, v57, v58
    v_max_u32 v12, v12, v59
    v_cmp_eq_u32 vcc, -1, v12
    s_cbranch_vccnz L_or6
L_ok6:
    v_mfma_f32_32x32x16_bf16 v[112:127], v[180:183], v[56:59], v[112:127]
    v_mfma_f32_32x32x16_bf16 v[96:111], v[176:179], v[56:59], v[96:111]
    s_waitcnt vmcnt(0)
L_oc7:
    v_max3_u32 v12, v60, v61, v62
    v_max_u32 v12, v12, v63
    v_cmp_eq_u32 vcc, -1, v12
    s_cbranch_vccnz L_or7
L_ok7:
    v_mfma_f32_32x32x16_bf16 v[112:127], v[188:191], v[60:63], v[112:127]
    v_mfma_f32_32x32x16_bf16 v[96:111], v[184:187], v[60:63], v[96:111]
    s_nop 10
    v_pk_fma_f32 v[88:89], v[120:121], v[14:15], v[88:89] op_sel_hi:[1,0,1]
    v_pk_fma_f32 v[90:91], v[122:123], v[14:15], v[90:91] op_sel_hi:[1,0,1]
    v_pk_fma_f32 v[92:93], v[124:125], v[14:15], v[92:93] op_sel_hi:[1,0,1]
    v_pk_fma_f32 v[94:95], v[126:127], v[14:15], v[94:95] op_sel_hi:[1,0,1]
    ds_write_b128 v22, v[88:91] offset:2048
    ds_write_b128 v22, v[92:95] offset:3072
    v_pk_fma_f32 v[80:81], v[112:113], v[14:15], v[80:81] op_sel_hi:[1,0,1]
    v_pk_fma_f32 v[82:83], v[114:115], v[14:15], v[82:83] op_sel_hi:[1,0,1]
    v_pk_fma_f32 v[84:85], v[116:117], v[14:15], v[84:85] op_sel_hi:[1,0,1]
    v_pk_fma_f32 v[86:87], v[118:119], v[14:15], v[86:87] op_sel_hi:[1,0,1]
    ds_write_b128 v22, v[80:83] offset:0
    ds_write_b128 v22, v[84:87] offset:1024
    v_pk_fma_f32 v[72:73], v[104:105], v[14:15], v[72:73] op_sel_hi:[1,0,1]
    v_pk_fma_f32 v[74:75], v[106:107], v[14:15], v[74:75] op_sel_hi:[1,0,1]
    v_pk_fma_f32 v[76:77], v[108:109], v[14:15], v[76:77] op_sel_hi:[1,0,1]
    v_pk_fma_f32 v[78:79], v[110:111], v[14:15], v[78:79] op_sel_hi:[1,0,1]
    ds_write_b128 v23, v[72:75] offset:2048
    ds_write_b128 v23, v[76:79] offset:3072
    v_pk_fma_f32 v[64:65], v[96:97], v[14:15], v[64:65] op_sel_hi:[1,0,1]
    v_pk_fma_f32 v[66:67], v[98:99], v[14:15], v[66:67] op_sel_hi:[1,0,1]
    v_pk_fma_f32 v[68:69], v[100:101], v[14:15], v[68:69] op_sel_hi:[1,0,1]
    v_pk_fma_f32 v[70:71], v[102:103], v[14:15], v[70:71] op_sel_hi:[1,0,1]
    s_waitcnt lgkmcnt(0)
    s_barrier
    ds_read_b128 v[104:107], v19 offset:2048
    ds_read_b128 v[108:111], v19 offset:3072
    ds_read_b128 v[112:115], v20 offset:0
    ds_read_b128 v[116:119], v20 offset:1024
    ds_read_b128 v[120:123], v21 offset:2048
    ds_read_b128 v[124:127], v21 offset:3072
    s_waitcnt lgkmcnt(4)
    v_pk_add_f32 v[64:65], v[64:65], v[104:105]
    v_pk_add_f32 v[66:67], v[66:67], v[106:107]
    v_pk_add_f32 v[68:69], v[68:69], v[108:109]
    v_pk_add_f32 v[70:71], v[70:71], v[110:111]
    s_waitcnt lgkmcnt(2)
    v_pk_add_f32 v[64:65], v[64:65], v[112:113]
    v_pk_add_f32 v[66:67], v[66:67], v[114:115]
    v_pk_add_f32 v[68:69], v[68:69], v[116:117]
    v_pk_add_f32 v[70:71], v[70:71], v[118:119]
    s_waitcnt lgkmcnt(0)
    v_pk_add_f32 v[64:65], v[64:65], v[120:121]
    v_pk_add_f32 v[66:67], v[66:67], v[122:123]
    v_pk_add_f32 v[68:69], v[68:69], v[124:125]
    v_pk_add_f32 v[70:71], v[70:71], v[126:127]
    v_cvt_pk_bf16_f32 v32, v64, v65
    v_cvt_pk_bf16_f32 v33, v66, v67
    v_cvt_pk_bf16_f32 v34, v68, v69
    v_cvt_pk_bf16_f32 v35, v70, v71
    buffer_store_dwordx4 v[32:35], v8, s[28:31], s70 offen
L_done:
    s_endpgm
Lrt_4:
    s_sub_u32 s58, s58, 1
    s_cbranch_scc1 Lok_5
    s_sleep 2
    v_mov_b32_e64 v18, 0
    buffer_load_dwordx2 v[26:27], v18, s[32:35], 0 offen sc1
    s_waitcnt vmcnt(0)
    s_branch Lchk_3
Lrt_8:
    s_sub_u32 s58, s58, 1
    s_cbranch_scc1 Lok_9
    s_sleep 2
    buffer_load_dwordx2 v[26:27], v21, s[16:19], s82 offen sc1
    s_waitcnt vmcnt(0)
    s_branch Lchk_7
Lrt_11:
    s_sub_u32 s58, s58, 1
    s_cbranch_scc1 Lok_12
    s_sleep 2
    v_mov_b32_e64 v18, 0
    buffer_load_dwordx2 v[26:27], v18, s[32:35], 0 offen sc1
    s_waitcnt vmcnt(0)
    s_branch Lchk_10
Lrt_15:
    s_sub_u32 s58, s58, 1
    s_cbranch_scc1 Lok_16
    s_sleep 2
    buffer_load_dwordx2 v[26:27], v21, s[16:19], s82 offen sc1
    s_waitcnt vmcnt(0)
    s_branch Lchk_14
Lrt_18:
    s_sub_u32 s58, s58, 1
    s_cbranch_scc1 Lok_19
    s_sleep 2
    buffer_load_dwordx2 v[26:27], v21, s[16:19], s80 offen sc1
    s_waitcnt vmcnt(0)
    s_branch Lchk_17
Lrt_21:
    s_sub_u32 s58, s58, 1
    s_cbranch_scc1 Lok_22
    s_sleep 2
    buffer_load_dwordx2 v[26:27], v21, s[16:19], s80 offen sc1
    s_waitcnt vmcnt(0)
    s_branch Lchk_20
L_or0:
    s_sub_u32 s58, s58, 1
    s_cbranch_scc1 L_ox0
    s_waitcnt vmcnt(0)
    s_sleep 2
    v_max3_u32 v12, v32, v33, v34
    v_max_u32 v12, v12, v35
    v_cmp_eq_u32 vcc, -1, v12
    s_mov_b64 exec, vcc
    buffer_load_dwordx4 v[32:35], v3, s[16:19], s71 offen offset:0 sc1
    s_mov_b64 exec, -1
    v_max3_u32 v12, v36, v37, v38
    v_max_u32 v12, v12, v39
    v_cmp_eq_u32 vcc, -1, v12
    s_mov_b64 exec, vcc
    buffer_load_dwordx4 v[36:39], v3, s[16:19], s71 offen offset:1024 sc1
    s_mov_b64 exec, -1
    v_max3_u32 v12, v40, v41, v42
    v_max_u32 v12, v12, v43
    v_cmp_eq_u32 vcc, -1, v12
    s_mov_b64 exec, vcc
    buffer_load_dwordx4 v[40:43], v3, s[16:19], s71 offen offset:2048 sc1
    s_mov_b64 exec, -1
    v_max3_u32 v12, v44, v45, v46
    v_max_u32 v12, v12, v47
    v_cmp_eq_u32 vcc, -1, v12
    s_mov_b64 exec, vcc
    buffer_load_dwordx4 v[44:47], v3, s[16:19], s71 offen offset:3072 sc1
    s_mov_b64 exec, -1
    v_max3_u32 v12, v48, v49, v50
    v_max_u32 v12, v12, v51
    v_cmp_eq_u32 vcc, -1, v12
    s_mov_b64 exec, vcc
    buffer_load_dwordx4 v[48:51], v3, s[16:19], s83 offen offset:0 sc1
    s_mov_b64 exec, -1
    v_max3_u32 v12, v52, v53, v54
    v_max_u32 v12, v12, v55
    v_cmp_eq_u32 vcc, -1, v12
    s_mov_b64 exec, vcc
    buffer_load_dwordx4 v[52:55], v3, s[16:19], s83 offen offset:1024 sc1
    s_mov_b64 exec, -1
    v_max3_u32 v12, v56, v57, v58
    v_max_u32 v12, v12, v59
    v_cmp_eq_u32 vcc, -1, v12
    s_mov_b64 exec, vcc
    buffer_load_dwordx4 v[56:59], v3, s[16:19], s83 offen offset:2048 sc1
    s_mov_b64 exec, -1
    v_max3_u32 v12, v60, v61, v62
    v_max_u32 v12, v12, v63
    v_cmp_eq_u32 vcc, -1, v12
    s_mov_b64 exec, vcc
    buffer_load_dwordx4 v[60:63], v3, s[16:19], s83 offen offset:3072 sc1
    s_mov_b64 exec, -1
    s_waitcnt vmcnt(0)
    s_branch L_oc0
L_ox0:
    s_mov_b32 s58, 0
    s_branch L_ok0
L_or1:
    s_sub_u32 s58, s58, 1
    s_cbranch_scc1 L_ox1
    s_waitcnt vmcnt(0)
    s_sleep 2
    v_max3_u32 v12, v36, v37, v38
    v_max_u32 v12, v12, v39
    v_cmp_eq_u32 vcc, -1, v12
    s_mov_b64 exec, vcc
    buffer_load_dwordx4 v[36:39], v3, s[16:19], s71 offen offset:1024 sc1
    s_mov_b64 exec, -1
    v_max3_u32 v12, v40, v41, v42
    v_max_u32 v12, v12, v43
    v_cmp_eq_u32 vcc, -1, v12
    s_mov_b64 exec, vcc
    buffer_load_dwordx4 v[40:43], v3, s[16:19], s71 offen offset:2048 sc1
    s_mov_b64 exec, -1
    v_max3_u32 v12, v44, v45, v46
    v_max_u32 v12, v12, v47
    v_cmp_eq_u32 vcc, -1, v12
    s_mov_b64 exec, vcc
    buffer_load_dwordx4 v[44:47], v3, s[16:19], s71 offen offset:3072 sc1
    s_mov_b64 exec, -1
    v_max3_u32 v12, v48, v49, v50
    v_max_u32 v12, v12, v51
    v_cmp_eq_u32 vcc, -1, v12
    s_mov_b64 exec, vcc
    buffer_load_dwordx4 v[48:51], v3, s[16:19], s83 offen offset:0 sc1
    s_mov_b64 exec, -1
    v_max3_u32 v12, v52, v53, v54
    v_max_u32 v12, v12, v55
    v_cmp_eq_u32 vcc, -1, v12
    s_mov_b64 exec, vcc
    buffer_load_dwordx4 v[52:55], v3, s[16:19], s83 offen offset:1024 sc1
    s_mov_b64 exec, -1
    v_max3_u32 v12, v56, v57, v58
    v_max_u32 v12, v12, v59
    v_cmp_eq_u32 vcc, -1, v12
    s_mov_b64 exec, vcc
    buffer_load_dwordx4 v[56:59], v3, s[16:19], s83 offen offset:2048 sc1
    s_mov_b64 exec, -1
    v_max3_u32 v12, v60, v61, v62
    v_max_u32 v12, v12, v63
    v_cmp_eq_u32 vcc, -1, v12
    s_mov_b64 exec, vcc
    buffer_load_dwordx4 v[60:63], v3, s[16:19], s83 offen offset:3072 sc1
    s_mov_b64 exec, -1
    s_waitcnt vmcnt(0)
    s_branch L_oc1
L_ox1:
    s_mov_b32 s58, 0
    s_branch L_ok1
L_or2:
    s_sub_u32 s58, s58, 1
    s_cbranch_scc1 L_ox2
    s_waitcnt vmcnt(0)
    s_sleep 2
    v_max3_u32 v12, v40, v41, v42
    v_max_u32 v12, v12, v43
    v_cmp_eq_u32 vcc, -1, v12
    s_mov_b64 exec, vcc
    buffer_load_dwordx4 v[40:43], v3, s[16:19], s71 offen offset:2048 sc1
    s_mov_b64 exec, -1
    v_max3_u32 v12, v44, v45, v46
    v_max_u32 v12, v12, v47
    v_cmp_eq_u32 vcc, -1, v12
    s_mov_b64 exec, vcc
    buffer_load_dwordx4 v[44:47], v3, s[16:19], s71 offen offset:3072 sc1
    s_mov_b64 exec, -1
    v_max3_u32 v12, v48, v49, v50
    v_max_u32 v12, v12, v51
    v_cmp_eq_u32 vcc, -1, v12
    s_mov_b64 exec, vcc
    buffer_load_dwordx4 v[48:51], v3, s[16:19], s83 offen offset:0 sc1
    s_mov_b64 exec, -1
    v_max3_u32 v12, v52, v53, v54
    v_max_u32 v12, v12, v55
    v_cmp_eq_u32 vcc, -1, v12
    s_mov_b64 exec, vcc
    buffer_load_dwordx4 v[52:55], v3, s[16:19], s83 offen offset:1024 sc1
    s_mov_b64 exec, -1
    v_max3_u32 v12, v56, v57, v58
    v_max_u32 v12, v12, v59
    v_cmp_eq_u32 vcc, -1, v12
    s_mov_b64 exec, vcc
    buffer_load_dwordx4 v[56:59], v3, s[16:19], s83 offen offset:2048 sc1
    s_mov_b64 exec, -1
    v_max3_u32 v12, v60, v61, v62
    v_max_u32 v12, v12, v63
    v_cmp_eq_u32 vcc, -1, v12
    s_mov_b64 exec, vcc
    buffer_load_dwordx4 v[60:63], v3, s[16:19], s83 offen offset:3072 sc1
    s_mov_b64 exec, -1
    s_waitcnt vmcnt(0)
    s_branch L_oc2
L_ox2:
    s_mov_b32 s58, 0
    s_branch L_ok2
L_or3:
    s_sub_u32 s58, s58, 1
    s_cbranch_scc1 L_ox3
    s_waitcnt vmcnt(0)
    s_sleep 2
    v_max3_u32 v12, v44, v45, v46
    v_max_u32 v12, v12, v47
    v_cmp_eq_u32 vcc, -1, v12
    s_mov_b64 exec, vcc
    buffer_load_dwordx4 v[44:47], v3, s[16:19], s71 offen offset:3072 sc1
    s_mov_b64 exec, -1
    v_max3_u32 v12, v48, v49, v50
    v_max_u32 v12, v12, v51
    v_cmp_eq_u32 vcc, -1, v12
    s_mov_b64 exec, vcc
    buffer_load_dwordx4 v[48:51], v3, s[16:19], s83 offen offset:0 sc1
    s_mov_b64 exec, -1
    v_max3_u32 v12, v52, v53, v54
    v_max_u32 v12, v12, v55
    v_cmp_eq_u32 vcc, -1, v12
    s_mov_b64 exec, vcc
    buffer_load_dwordx4 v[52:55], v3, s[16:19], s83 offen offset:1024 sc1
    s_mov_b64 exec, -1
    v_max3_u32 v12, v56, v57, v58
    v_max_u32 v12, v12, v59
    v_cmp_eq_u32 vcc, -1, v12
    s_mov_b64 exec, vcc
    buffer_load_dwordx4 v[56:59], v3, s[16:19], s83 offen offset:2048 sc1
    s_mov_b64 exec, -1
    v_max3_u32 v12, v60, v61, v62
    v_max_u32 v12, v12, v63
    v_cmp_eq_u32 vcc, -1, v12
    s_mov_b64 exec, vcc
    buffer_load_dwordx4 v[60:63], v3, s[16:19], s83 offen offset:3072 sc1
    s_mov_b64 exec, -1
    s_waitcnt vmcnt(0)
    s_branch L_oc3
L_ox3:
    s_mov_b32 s58, 0
    s_branch L_ok3
L_or4:
    s_sub_u32 s58, s58, 1
    s_cbranch_scc1 L_ox4
    s_waitcnt vmcnt(0)
    s_sleep 2
    v_max3_u32 v12, v48, v49, v50
    v_max_u32 v12, v12, v51
    v_cmp_eq_u32 vcc, -1, v12
    s_mov_b64 exec, vcc
    buffer_load_dwordx4 v[48:51], v3, s[16:19], s83 offen offset:0 sc1
    s_mov_b64 exec, -1
    v_max3_u32 v12, v52, v53, v54
    v_max_u32 v12, v12, v55
    v_cmp_eq_u32 vcc, -1, v12
    s_mov_b64 exec, vcc
    buffer_load_dwordx4 v[52:55], v3, s[16:19], s83 offen offset:1024 sc1
    s_mov_b64 exec, -1
    v_max3_u32 v12, v56, v57, v58
    v_max_u32 v12, v12, v59
    v_cmp_eq_u32 vcc, -1, v12
    s_mov_b64 exec, vcc
    buffer_load_dwordx4 v[56:59], v3, s[16:19], s83 offen offset:2048 sc1
    s_mov_b64 exec, -1
    v_max3_u32 v12, v60, v61, v62
    v_max_u32 v12, v12, v63
    v_cmp_eq_u32 vcc, -1, v12
    s_mov_b64 exec, vcc
    buffer_load_dwordx4 v[60:63], v3, s[16:19], s83 offen offset:3072 sc1
    s_mov_b64 exec, -1
    s_waitcnt vmcnt(0)
    s_branch L_oc4
L_ox4:
    s_mov_b32 s58, 0
    s_branch L_ok4
L_or5:
    s_sub_u32 s58, s58, 1
    s_cbranch_scc1 L_ox5
    s_waitcnt vmcnt(0)
    s_sleep 2
    v_max3_u32 v12, v52, v53, v54
    v_max_u32 v12, v12, v55
    v_cmp_eq_u32 vcc, -1, v12
    s_mov_b64 exec, vcc
    buffer_load_dwordx4 v[52:55], v3, s[16:19], s83 offen offset:1024 sc1
    s_mov_b64 exec, -1
    v_max3_u32 v12, v56, v57, v58
    v_max_u32 v12, v12, v59
    v_cmp_eq_u32 vcc, -1, v12
    s_mov_b64 exec, vcc
    buffer_load_dwordx4 v[56:59], v3, s[16:19], s83 offen offset:2048 sc1
    s_mov_b64 exec, -1
    v_max3_u32 v12, v60, v61, v62
    v_max_u32 v12, v12, v63
    v_cmp_eq_u32 vcc, -1, v12
    s_mov_b64 exec, vcc
    buffer_load_dwordx4 v[60:63], v3, s[16:19], s83 offen offset:3072 sc1
    s_mov_b64 exec, -1
    s_waitcnt vmcnt(0)
    s_branch L_oc5
L_ox5:
    s_mov_b32 s58, 0
    s_branch L_ok5
L_or6:
    s_sub_u32 s58, s58, 1
    s_cbranch_scc1 L_ox6
    s_waitcnt vmcnt(0)
    s_sleep 2
    v_max3_u32 v12, v56, v57, v58
    v_max_u32 v12, v12, v59
    v_cmp_eq_u32 vcc, -1, v12
    s_mov_b64 exec, vcc
    buffer_load_dwordx4 v[56:59], v3, s[16:19], s83 offen offset:2048 sc1
    s_mov_b64 exec, -1
    v_max3_u32 v12, v60, v61, v62
    v_max_u32 v12, v12, v63
    v_cmp_eq_u32 vcc, -1, v12
    s_mov_b64 exec, vcc
    buffer_load_dwordx4 v[60:63], v3, s[16:19], s83 offen offset:3072 sc1
    s_mov_b64 exec, -1
    s_waitcnt vmcnt(0)
    s_branch L_oc6
L_ox6:
    s_mov_b32 s58, 0
    s_branch L_ok6
L_or7:
    s_sub_u32 s58, s58, 1
    s_cbranch_scc1 L_ox7
    s_waitcnt vmcnt(0)
    s_sleep 2
    v_max3_u32 v12, v60, v61, v62
    v_max_u32 v12, v12, v63
    v_cmp_eq_u32 vcc, -1, v12
    s_mov_b64 exec, vcc
    buffer_load_dwordx4 v[60:63], v3, s[16:19], s83 offen offset:3072 sc1
    s_mov_b64 exec, -1
    s_waitcnt vmcnt(0)
    s_branch L_oc7
L_ox7:
    s_mov_b32 s58, 0
    s_branch L_ok7
L_end:
L_slow:
    s_waitcnt lgkmcnt(0)
    v_mov_b32 v12, 0xff800000
    s_mov_b32 s53, 64
    s_mov_b32 s44, s59
L_smax:
    buffer_load_dwordx4 v[192:195], v3, s[16:19], s44 offen sc1
    s_waitcnt vmcnt(0)
    v_mfma_f32_32x32x16_bf16 v[144:159], v[192:195], v[4:7], 0
    s_add_u32 s44, s44, 2048
    s_nop 15
    v_max3_f32 v12, v12, v144, v145
    v_max3_f32 v12, v12, v146, v147
    v_max3_f32 v12, v12, v148, v149
    v_max3_f32 v12, v12, v150, v151
    v_max3_f32 v12, v12, v152, v153
    v_max3_f32 v12, v12, v154, v155
    v_max3_f32 v12, v12, v156, v157
    v_max3_f32 v12, v12, v158, v159
    s_sub_u32 s53, s53, 1
    s_cmp_lg_u32 s53, 0
    s_cbranch_scc1 L_smax
    v_mov_b32 v13, v12
    s_nop 1
    v_permlane32_swap_b32 v12, v13
    s_nop 1
    v_max_f32 v12, v12, v13
    v_sub_f32 v128, 0, v12
    v_sub_f32 v129, 0, v12
    v_sub_f32 v130, 0, v12
    v_sub_f32 v131, 0, v12
    v_sub_f32 v132, 0, v12
    v_sub_f32 v133, 0, v12
    v_sub_f32 v134, 0, v12
    v_sub_f32 v135, 0, v12
    v_sub_f32 v136, 0, v12
    v_sub_f32 v137, 0, v12
    v_sub_f32 v138, 0, v12
    v_sub_f32 v139, 0, v12
    v_sub_f32 v140, 0, v12
    v_sub_f32 v141, 0, v12
    v_sub_f32 v142, 0, v12
    v_sub_f32 v143, 0, v12
    v_mov_b32 v176, 0
    v_mov_b32 v177, 0
    v_mov_b32 v178, 0
    v_mov_b32 v179, 0
    v_mov_b32 v180, 0
    v_mov_b32 v181, 0
    v_mov_b32 v182, 0
    v_mov_b32 v183, 0
    v_mov_b32 v184, 0
    v_mov_b32 v185, 0
    v_mov_b32 v186, 0
    v_mov_b32 v187, 0
    v_mov_b32 v188, 0
    v_mov_b32 v189, 0
    v_mov_b32 v190, 0
    v_mov_b32 v191, 0
    v_subrev_u32 v9, 98304, v9
    s_mov_b32 s53, 64
    s_mov_b32 s44, s59
L_smain:
    buffer_load_dwordx4 v[192:195], v3, s[16:19], s44 offen sc1
    s_mov_b64 exec, s[50:51]
    buffer_load_dwordx4 v[200:203], v9, s[16:19], s44 offen sc1
    buffer_load_dwordx4 v[204:207], v9, s[16:19], s44 offen offset:512 sc1
    s_mov_b64 exec, -1
    s_waitcnt vmcnt(0)
    v_mfma_f32_32x32x16_bf16 v[144:159], v[192:195], v[4:7], v[128:143]
    s_add_u32 s44, s44, 2048
    s_nop 15
    v_exp_f32 v144, v144
    v_exp_f32 v145, v145
    v_exp_f32 v146, v146
    v_exp_f32 v147, v147
    v_exp_f32 v148, v148
    v_exp_f32 v149, v149
    v_exp_f32 v150, v150
    v_exp_f32 v151, v151
    v_exp_f32 v152, v152
    v_exp_f32 v153, v153
    v_exp_f32 v154, v154
    v_exp_f32 v155, v155
    v_exp_f32 v156, v156
    v_exp_f32 v157, v157
    v_exp_f32 v158, v158
    v_exp_f32_e64 v159, v159
    s_nop 0
    v_cvt_pk_bf16_f32 v216, v144, v145
    v_cvt_pk_bf16_f32 v217, v146, v147
    v_cvt_pk_bf16_f32 v218, v148, v149
    v_cvt_pk_bf16_f32 v219, v150, v151
    v_cvt_pk_bf16_f32 v220, v152, v153
    v_cvt_pk_bf16_f32 v221, v154, v155
    v_cvt_pk_bf16_f32 v222, v156, v157
    v_cvt_pk_bf16_f32 v223, v158, v159
    s_nop 1
    v_mfma_f32_32x32x16_bf16 v[176:191], v[200:203], v[216:219], v[176:191]
    v_mfma_f32_32x32x16_bf16 v[176:191], v[204:207], v[220:223], v[176:191]
    s_sub_u32 s53, s53, 1
    s_cmp_lg_u32 s53, 0
    s_cbranch_scc1 L_smain
    s_nop 15
    s_branch L_fin
.section .rodata,"a"
.p2align 6
.amdhsa_kernel gated_mix__softmax_full_mha__glu_gated_bilinear__prompt_kernel
  .amdhsa_next_free_vgpr 256
  .amdhsa_next_free_sgpr 102
  .amdhsa_accum_offset 256
  .amdhsa_group_segment_fixed_size 0
  .amdhsa_kernarg_size 88
  .amdhsa_user_sgpr_count 2
  .amdhsa_user_sgpr_kernarg_segment_ptr 1
  .amdhsa_system_sgpr_workgroup_id_x 1
.end_amdhsa_kernel
```
